```python
import torch

def _softmax(x, axis=-1):
    return torch.softmax(x, dim=axis)
def _gelu(x):
    return torch.nn.functional.gelu(x, approximate="tanh")
def _silu(x):
    return torch.nn.functional.silu(x)
def _sigmoid(x):
    return torch.sigmoid(x)
def _layernorm(x, axis=-1, eps=1e-5):
    m = x.mean(dim=axis, keepdim=True)
    v = x.var(dim=axis, keepdim=True, unbiased=False)
    return (x - m) / torch.sqrt(v + eps)
def _scatter_add(tgt, idx, src, axis=0):
    return tgt.clone().index_add_(axis, idx, src)
def _segment_sum(src, seg, n):
    out = torch.zeros((n,) + src.shape[1:], dtype=src.dtype)
    return out.index_add_(0, seg, src)
def _pad(x, pw):
    flat = tuple(v for pair in reversed(pw) for v in pair)
    return torch.nn.functional.pad(x, flat)

kernel_name = 'concat_heads__ssm_conv_s4d__linear_attn_block__prompt'

def setup_inputs():

    _w = (lambda a: (lambda t: t.to(torch.bfloat16) if t.is_floating_point() else t)(torch.as_tensor(a)))
    def _A_setup():
        Bsz, L, D, N = 1, 2048, 576, 128
        return {
            "u": _w((lambda *s: torch.randn(*s, dtype=torch.bfloat16) * 0.05)(Bsz, L, D)),
            "log_A_real": _w((lambda *s: torch.randn(*s, dtype=torch.bfloat16) * 6.4)(D, N) * 0.5),
            "A_imag": _w((lambda *s: torch.randn(*s, dtype=torch.bfloat16) * 0.05)(D, N) * 3.14),
            "C_real": _w((lambda *s: torch.randn(*s, dtype=torch.bfloat16) * 0.1)(D, N) / N ** 0.5),
            "C_imag": _w((lambda *s: torch.randn(*s, dtype=torch.bfloat16) * 0.1)(D, N) / N ** 0.5),
            "log_dt": _w((lambda *s: torch.randn(*s, dtype=torch.bfloat16) * 0.05)(D) * 0.5 - 4.0),
            "D_skip": _w((lambda *s: torch.randn(*s, dtype=torch.bfloat16) * 0.05)(D)),
        }
    _A_in = _A_setup()

    def _B_setup():
        B, S, D = 1, 2048, 576
        return {
            "x": _w((lambda *s: torch.randn(*s, dtype=torch.bfloat16) * 0.05)(B, S, D)),
            "wqkv": _w((lambda *s: torch.randn(*s, dtype=torch.bfloat16) * 0.4)(D, 3 * D)),
            "wo": _w((lambda *s: torch.randn(*s, dtype=torch.bfloat16) * 0.05)(D, D)),
        }
    _B_in = _B_setup()

    return {
        "A_u": _A_in["u"],
        "A_log_A_real": _A_in["log_A_real"],
        "A_A_imag": _A_in["A_imag"],
        "A_C_real": _A_in["C_real"],
        "A_C_imag": _A_in["C_imag"],
        "A_log_dt": _A_in["log_dt"],
        "A_D_skip": _A_in["D_skip"],
        "B_x": _B_in["x"],
        "B_wqkv": _B_in["wqkv"],
        "B_wo": _B_in["wo"],
    }

def reference(A_u, A_log_A_real, A_A_imag, A_C_real, A_C_imag, A_log_dt, A_D_skip, B_x, B_wqkv, B_wo):
    def _A_ref(u, log_A_real, A_imag, C_real, C_imag, log_dt, D_skip):
        L = u.shape[1]
        dt = torch.exp(log_dt)
        A = -torch.exp(log_A_real) + 1j * A_imag
        C = (C_real + 1j * C_imag) * dt[:, None]
        pos = (lambda x, dt: x.to(dt))(torch.arange(L), log_dt.dtype)
        P = torch.exp((A * dt[:, None])[:, :, None] * pos[None, None, :])
        K = 2.0 * torch.einsum("dn,dnl->dl", C, P).real
        L2 = 2 * L
        u_t = (lambda x, *d: x.permute(*d))(u, 0, 2, 1)
        Kf = (lambda x, *a, **k: torch.fft.rfft(x.float(), *a, **k))(K, L2)
        Uf = (lambda x, *a, **k: torch.fft.rfft(x.float(), *a, **k))(u_t, L2)
        y = (lambda x, *a, **k: torch.fft.irfft(x, *a, **k).to(torch.bfloat16))(Uf * Kf[None, :, :], L2)[:, :, :L]
        y = (lambda x, *d: x.permute(*d))(y, 0, 2, 1)
        return y + u * D_skip[None, None, :]

    def _B_ref(x, wqkv, wo):
        B, S, D = x.shape
        H = 32; Dh = D // H
        qkv = (lambda x, *d: x.permute(*d))((x @ wqkv).reshape(B, S, 3, H, Dh), 2, 0, 3, 1, 4)
        q, k, v = qkv[0], qkv[1], qkv[2]
        phi = lambda t: torch.where(t > 0, t + 1, torch.exp(t)) + 1e-6
        pq, pk = phi(q), phi(k)
        kv = torch.einsum("bhsd,bhse->bhde", pk, v)
        z = torch.einsum("bhsd->bhd", pk)
        num = torch.einsum("bhqd,bhde->bhqe", pq, kv)
        den = torch.einsum("bhqd,bhd->bhq", pq, z)[..., None] + 1e-6
        o = num / den
        return (lambda x, *d: x.permute(*d))(o, 0, 2, 1, 3).reshape(B, S, D) @ wo

    a = _A_ref(A_u, A_log_A_real, A_A_imag, A_C_real, A_C_imag, A_log_dt, A_D_skip)
    b = _B_ref(B_x, B_wqkv, B_wo)
    return torch.concatenate([a, b], axis=-1)
```

```asm
; @launch grid=(256,1,1) block=(768,1,1) lds=163840
.amdgcn_target "amdgcn-amd-amdhsa--gfx950"
.text
.globl concat_heads__ssm_conv_s4d__linear_attn_block__prompt_kernel
.p2align 8
.type concat_heads__ssm_conv_s4d__linear_attn_block__prompt_kernel,@function
concat_heads__ssm_conv_s4d__linear_attn_block__prompt_kernel:
    s_load_dwordx16 s[16:31], s[0:1], 0
    s_load_dwordx8 s[32:39], s[0:1], 64
    s_load_dwordx2 s[40:41], s[0:1], 96
    s_cmp_ge_u32 s2, 256
    s_cbranch_scc1 L_exit
    v_lshrrev_b32 v1, 6, v0
    v_and_b32 v0, 63, v0
    v_readfirstlane_b32 s3, v1
    s_and_b32 s4, s2, 7
    s_lshr_b32 s5, s2, 3
    s_cmp_ge_u32 s5, 22
    s_cbranch_scc1 L_A
    s_mul_i32 s6, s5, 12
    s_add_u32 s6, s6, s3
    s_lshl_b32 s6, s6, 10
    s_cmp_ge_u32 s6, L_codeend-L_pc-1024
    s_cbranch_scc1 L_npf
    s_getpc_b64 s[8:9]
L_pc:
    s_sub_u32 s6, L_codeend-L_pc-1024, s6
    v_lshl_add_u32 v2, v0, 4, s6
    global_load_dwordx4 v[164:167], v2, s[8:9]
L_npf:
    s_lshr_b32 s6, s4, 1
    s_lshl_b32 s6, s6, 2
    s_and_b32 s11, s4, 1
    s_and_b32 s12, s5, 3
    s_lshr_b32 s7, s5, 2
    s_lshl_b32 s10, s11, 2
    s_add_u32 s10, s10, s7
    s_lshl_b32 s14, s11, 1
    s_add_u32 s15, s14, s12
    s_cmp_eq_u32 s7, 5
    s_cselect_b32 s12, s15, s12
    s_cselect_b32 s14, 1, s14
    s_add_u32 s6, s6, s12
    s_cmp_ge_u32 s7, 4
    s_cselect_b32 s10, s14, s10
    s_cselect_b32 s13, 1, 0
    s_cmp_lt_u32 s3, 4
    s_cbranch_scc1 L_comp
    s_sub_u32 s71, s3, 4
    v_lshrrev_b32 v2, 3, v0
    v_mul_u32_u24 v2, 1152, v2
    v_lshrrev_b32 v3, 4, v0
    v_and_b32 v4, 7, v0
    v_xor_b32 v3, v3, v4
    v_lshl_add_u32 v2, v3, 4, v2
    v_xor_b32 v3, 64, v2
    s_cmp_eq_u32 s13, 0
    s_cselect_b32 s60, 18, 24
    s_mov_b32 s61, 2731
    s_cselect_b32 s61, 3641, s61
    s_and_b32 s15, s71, 1
    s_lshl_b32 s15, s15, 2
    s_cmp_eq_u32 s13, 0
    s_cselect_b32 s15, s15, 0
    s_cselect_b32 s62, 0, 4
    s_cselect_b32 s9, 1008, 0
    s_lshl_b32 s42, s71, 3
    v_mov_b32 v10, s9
    v_add_u32 v7, 0, v0
    v_mul_u32_u24 v8, s61, v7
    v_lshrrev_b32 v8, 16, v8
    v_mul_u32_u24 v9, s60, v8
    v_sub_u32 v9, v7, v9
    v_lshlrev_b32 v11, 1, v8
    v_and_b32 v11, s62, v11
    v_xor_b32 v9, v9, v11
    v_xor_b32 v8, s15, v8
    v_add_u32 v8, s42, v8
    v_mul_u32_u24 v8, 3456, v8
    v_lshl_add_u32 v8, v9, 4, v8
    v_cmp_lt_u32 vcc, 8, v9
    s_nop 1
    v_cndmask_b32 v9, 0, v10, vcc
    v_add_u32 v4, v8, v9
    v_add_u32 v7, 64, v0
    v_mul_u32_u24 v8, s61, v7
    v_lshrrev_b32 v8, 16, v8
    v_mul_u32_u24 v9, s60, v8
    v_sub_u32 v9, v7, v9
    v_lshlrev_b32 v11, 1, v8
    v_and_b32 v11, s62, v11
    v_xor_b32 v9, v9, v11
    v_xor_b32 v8, s15, v8
    v_add_u32 v8, s42, v8
    v_mul_u32_u24 v8, 3456, v8
    v_lshl_add_u32 v8, v9, 4, v8
    v_cmp_lt_u32 vcc, 8, v9
    s_nop 1
    v_cndmask_b32 v9, 0, v10, vcc
    v_add_u32 v5, v8, v9
    v_subrev_u32 v5, 1024, v5
    v_add_u32 v7, 128, v0
    v_mul_u32_u24 v8, s61, v7
    v_lshrrev_b32 v8, 16, v8
    v_mul_u32_u24 v9, s60, v8
    v_sub_u32 v9, v7, v9
    v_lshlrev_b32 v11, 1, v8
    v_and_b32 v11, s62, v11
    v_xor_b32 v9, v9, v11
    v_xor_b32 v8, s15, v8
    v_add_u32 v8, s42, v8
    v_mul_u32_u24 v8, 3456, v8
    v_lshl_add_u32 v8, v9, 4, v8
    v_cmp_lt_u32 vcc, 8, v9
    s_nop 1
    v_cndmask_b32 v9, 0, v10, vcc
    v_add_u32 v6, v8, v9
    v_subrev_u32 v6, 2048, v6
    s_mul_i32 s60, s10, 144
    s_add_u32 s60, s60, 1152
    s_mul_i32 s61, s10, 384
    s_mul_i32 s63, s71, 2304
    s_mul_i32 s64, s71, 3072
    s_mov_b32 s72, 40960
    s_movk_i32 s73, 0x6000
    s_cmp_eq_u32 s13, 0
    s_cselect_b32 s60, s60, s61
    s_cselect_b32 s63, s63, s64
    s_cselect_b32 s72, 34816, s72
    s_cselect_b32 s73, 18432, s73
    s_cselect_b32 s74, 0xffff, -1
    s_cselect_b32 s75, 0, -1
    s_lshl_b32 s64, s71, 11
    s_add_u32 s64, s64, s73
    s_lshl_b32 s61, s6, 3
    s_add_u32 s61, s61, s71
    s_mul_i32 s61, s61, 18432
    s_and_b32 s66, s6, 3
    s_mul_i32 s66, s66, 8
    s_mul_i32 s67, s7, 4
    s_lshr_b32 s66, s66, 2
    s_lshr_b32 s67, s67, 2
    s_add_u32 s66, s66, s67
    s_cmp_ge_u32 s66, 8
    s_cselect_b32 s67, 8, 0
    s_sub_u32 s66, s66, s67
    s_add_u32 s70, s66, 1
    s_mov_b32 s66, 0
    s_mov_b32 s65, 0
    s_waitcnt lgkmcnt(0)
    s_mov_b32 s44, s30
    s_mov_b32 s45, s31
    s_mov_b32 s46, 2359296
    s_mov_b32 s47, 0x20000
    s_mov_b32 s48, s32
    s_mov_b32 s49, s33
    s_mov_b32 s50, 1990656
    s_mov_b32 s51, 0x20000
L_ld:
    s_and_b32 s67, s65, 3
    s_mul_i32 s67, s67, s72
    s_add_u32 m0, s63, s67
    s_mul_i32 s68, s66, 221184
    s_add_u32 s68, s68, s60
    buffer_load_dwordx4 v4, s[48:51], s68 offen lds
    buffer_load_dwordx4 v5, s[48:51], s68 offen offset:1024 lds
    s_mov_b64 exec, s[74:75]
    buffer_load_dwordx4 v6, s[48:51], s68 offen offset:2048 lds
    s_mov_b64 exec, -1
    s_add_u32 m0, s64, s67
    s_lshl_b32 s68, s66, 7
    s_add_u32 s68, s68, s61
    s_add_u32 s69, s68, 8192
    buffer_load_dwordx4 v2, s[44:47], s68 offen lds
    buffer_load_dwordx4 v3, s[44:47], s69 offen offset:1024 lds
    s_add_u32 s66, s66, 1
    s_cmp_eq_u32 s65, 0
    s_cselect_b32 s66, s70, s66
    s_cmp_eq_u32 s66, 9
    s_cselect_b32 s66, 1, s66
    s_add_u32 s65, s65, 1
    s_cmp_eq_u32 s65, 1
    s_cbranch_scc1 L_ld
    s_cmp_lt_u32 s65, 9
    s_waitcnt vmcnt(5)
    s_barrier
    s_cbranch_scc1 L_ld
    s_mov_b32 s76, s38
    s_mov_b32 s77, s39
    s_mov_b32 s78, 256
    s_mov_b32 s79, 0x20000
    v_lshlrev_b32 v13, 5, v0
    s_and_b32 s67, s3, 3
    s_cbranch_scc1 L_ldx
    s_mov_b64 exec, 0xff
    buffer_load_dword v14, v13, s[76:79], 0 offen sc0 sc1
    s_mov_b64 exec, -1
    s_waitcnt vmcnt(1)
    s_branch L_ldy
L_ldx:
    s_waitcnt vmcnt(0)
L_ldy:
    s_barrier
    s_cmp_lt_u32 s7, 5
    s_cbranch_scc1 L_help
    s_cmp_eq_u32 s3, 4
    s_cbranch_scc1 L_help
L_exit:
    s_endpgm
L_comp:
    v_lshrrev_b32 v5, 4, v0
    v_and_b32 v6, 15, v0
    s_cmp_lg_u32 s13, 0
    s_cbranch_scc1 L_q
    v_lshrrev_b32 v7, 2, v6
    v_lshl_add_u32 v7, v5, 3, v7
    v_and_b32 v8, 1, v5
    v_lshl_add_u32 v2, v8, 2, v7
    v_xor_b32 v3, 4, v2
    v_mul_u32_u24 v2, 288, v2
    v_mul_u32_u24 v3, 288, v3
    v_and_b32 v8, 3, v0
    v_lshl_add_u32 v2, v8, 3, v2
    v_lshl_add_u32 v3, v8, 3, v3
    v_lshrrev_b32 v8, 1, v6
    v_xor_b32 v8, v8, v5
    v_lshlrev_b32 v4, 7, v6
    v_lshl_add_u32 v4, v8, 4, v4
    s_lshl_b32 s14, s3, 12
    s_add_u32 s14, s14, 18432
    v_add_u32 v4, s14, v4
    v_lshlrev_b32 v13, 2, v0
    v_mul_u32_u24 v10, 8192, v0
    v_mov_b32 v11, 1
    v_mov_b32 v15, 77312
    s_mul_i32 s14, s3, 9216
    s_add_u32 s14, s14, 34816
    v_lshlrev_b32 v14, 4, v0
    v_add_u32 v12, s14, v14
    s_lshl_b32 s14, s3, 10
    s_add_u32 s14, s14, 34816
    v_add_u32 v148, s14, v14
    s_mul_i32 s14, s3, 4356
    v_mul_u32_u24 v149, 528, v5
    v_lshl_add_u32 v149, v6, 2, v149
    v_add_u32 v149, s14, v149
    s_mul_i32 s15, s3, 272
    s_add_u32 s15, s15, s14
    s_add_u32 s15, s15, 1056
    s_lshl_b32 s60, s3, 3
    s_add_u32 s60, s60, s14
    s_add_u32 s60, s60, 2928
    v_add_u32 v7, 0, v0
    v_mul_u32_u24 v8, 3641, v7
    v_lshrrev_b32 v8, 16, v8
    v_mul_u32_u24 v8, 60, v8
    v_lshl_add_u32 v8, v7, 2, v8
    v_add_u32 v150, s15, v8
    v_add_u32 v7, 64, v0
    v_mul_u32_u24 v8, 3641, v7
    v_lshrrev_b32 v8, 16, v8
    v_mul_u32_u24 v8, 60, v8
    v_lshl_add_u32 v8, v7, 2, v8
    v_add_u32 v151, s15, v8
    v_add_u32 v7, 128, v0
    v_mul_u32_u24 v8, 3641, v7
    v_lshrrev_b32 v8, 16, v8
    v_mul_u32_u24 v8, 60, v8
    v_lshl_add_u32 v8, v7, 2, v8
    v_add_u32 v152, s15, v8
    v_add_u32 v7, 192, v0
    v_mul_u32_u24 v8, 3641, v7
    v_lshrrev_b32 v8, 16, v8
    v_mul_u32_u24 v8, 60, v8
    v_lshl_add_u32 v8, v7, 2, v8
    v_add_u32 v153, s15, v8
    v_add_u32 v7, 256, v0
    v_mul_u32_u24 v8, 3641, v7
    v_lshrrev_b32 v8, 16, v8
    v_mul_u32_u24 v8, 60, v8
    v_lshl_add_u32 v8, v7, 2, v8
    v_add_u32 v154, s15, v8
    v_add_u32 v7, 320, v0
    v_mul_u32_u24 v8, 3641, v7
    v_lshrrev_b32 v8, 16, v8
    v_mul_u32_u24 v8, 60, v8
    v_lshl_add_u32 v8, v7, 2, v8
    v_add_u32 v155, s15, v8
    v_lshl_add_u32 v8, v7, 2, s60
    v_cmp_le_u32 vcc, 4, v0
    s_nop 1
    v_cndmask_b32 v155, v155, v8, vcc
    v_mov_b32 v156, 0x3f803f80
    v_mov_b32 v157, 0x3f803f80
    v_mov_b32 v158, 0x3f803f80
    v_mov_b32 v159, 0x3f803f80
    s_lshl_b32 s14, s10, 2
    s_add_u32 s14, s14, s3
    s_mul_i32 s57, s10, 1024
    s_add_u32 s57, s57, 3276800
    s_mul_i32 s56, s14, 1408
    s_add_u32 s56, s56, 2359296
    s_mov_b32 s68, 0x3fb8aa3b
    s_mov_b32 s69, 0x3fb8aa3b
    s_mov_b32 s70, 0x358637bd
    v_mov_b64 v[16:17], 0
    v_mov_b64 v[18:19], 0
    v_mov_b64 v[20:21], 0
    v_mov_b64 v[22:23], 0
    v_mov_b64 v[24:25], 0
    v_mov_b64 v[26:27], 0
    v_mov_b64 v[28:29], 0
    v_mov_b64 v[30:31], 0
    v_mov_b64 v[32:33], 0
    v_mov_b64 v[34:35], 0
    v_mov_b64 v[36:37], 0
    v_mov_b64 v[38:39], 0
    v_mov_b64 v[40:41], 0
    v_mov_b64 v[42:43], 0
    v_mov_b64 v[44:45], 0
    v_mov_b64 v[46:47], 0
    v_mov_b64 v[48:49], 0
    v_mov_b64 v[50:51], 0
    v_mov_b64 v[52:53], 0
    v_mov_b64 v[54:55], 0
    v_mov_b64 v[56:57], 0
    v_mov_b64 v[58:59], 0
    v_mov_b64 v[60:61], 0
    v_mov_b64 v[62:63], 0
    v_mov_b64 v[64:65], 0
    v_mov_b64 v[66:67], 0
    v_mov_b64 v[68:69], 0
    v_mov_b64 v[70:71], 0
    v_mov_b64 v[72:73], 0
    v_mov_b64 v[74:75], 0
    v_mov_b64 v[76:77], 0
    v_mov_b64 v[78:79], 0
    v_mov_b64 v[80:81], 0
    v_mov_b64 v[82:83], 0
    v_mov_b64 v[84:85], 0
    v_mov_b64 v[86:87], 0
    s_mov_b32 s65, 0
    s_mov_b32 s67, 34816
    s_waitcnt lgkmcnt(0)
    s_mov_b32 s52, s40
    s_mov_b32 s53, s41
    s_mov_b32 s54, 268435456
    s_mov_b32 s55, 0x20000
    s_barrier
    ds_read_b128 v[124:127], v4 offset:0
    ds_read_b128 v[128:131], v4 offset:2048
    ds_read_b64_tr_b16 v[88:89], v2 offset:0
    ds_read_b64_tr_b16 v[90:91], v3 offset:0
    ds_read_b64_tr_b16 v[92:93], v2 offset:32
    ds_read_b64_tr_b16 v[94:95], v3 offset:32
    ds_read_b64_tr_b16 v[96:97], v2 offset:64
    ds_read_b64_tr_b16 v[98:99], v3 offset:64
    ds_read_b64_tr_b16 v[100:101], v2 offset:96
    ds_read_b64_tr_b16 v[102:103], v3 offset:96
    ds_read_b64_tr_b16 v[104:105], v2 offset:128
    ds_read_b64_tr_b16 v[106:107], v3 offset:128
    ds_read_b64_tr_b16 v[108:109], v2 offset:160
    ds_read_b64_tr_b16 v[110:111], v3 offset:160
    ds_read_b64_tr_b16 v[112:113], v2 offset:192
    ds_read_b64_tr_b16 v[114:115], v3 offset:192
    ds_read_b64_tr_b16 v[116:117], v2 offset:224
    ds_read_b64_tr_b16 v[118:119], v3 offset:224
    v_mov_b32 v7, v2
    v_mov_b32 v8, v3
    v_xor_b32 v9, 64, v4
L_kvloop:
    s_waitcnt lgkmcnt(10)
    v_mfma_f32_16x16x32_bf16 v[16:19], v[124:127], v[88:91], v[16:19]
    ds_read_b64_tr_b16 v[120:121], v2 offset:256
    v_mfma_f32_16x16x32_bf16 v[20:23], v[128:131], v[88:91], v[20:23]
    ds_read_b64_tr_b16 v[122:123], v3 offset:256
    v_mfma_f32_16x16x32_bf16 v[24:27], v[124:127], v[92:95], v[24:27]
    ds_read_b64_tr_b16 v[88:89], v7 offset:9216
    ds_read_b128 v[132:135], v9 offset:0
    v_mfma_f32_16x16x32_bf16 v[28:31], v[128:131], v[92:95], v[28:31]
    ds_read_b64_tr_b16 v[90:91], v8 offset:9216
    v_mfma_f32_16x16x32_bf16 v[32:35], v[124:127], v[96:99], v[32:35]
    ds_read_b64_tr_b16 v[92:93], v7 offset:9248
    v_mfma_f32_16x16x32_bf16 v[36:39], v[128:131], v[96:99], v[36:39]
    ds_read_b64_tr_b16 v[94:95], v8 offset:9248
    s_add_u32 s65, s65, 1
    s_and_b32 s66, s65, 3
    s_cselect_b32 s66, s67, 4294862848
    s_waitcnt lgkmcnt(11)
    v_mfma_f32_16x16x32_bf16 v[40:43], v[124:127], v[100:103], v[40:43]
    ds_read_b64_tr_b16 v[96:97], v7 offset:9280
    ds_read_b128 v[136:139], v9 offset:2048
    v_mfma_f32_16x16x32_bf16 v[44:47], v[128:131], v[100:103], v[44:47]
    ds_read_b64_tr_b16 v[98:99], v8 offset:9280
    v_mfma_f32_16x16x32_bf16 v[48:51], v[124:127], v[104:107], v[48:51]
    ds_read_b64_tr_b16 v[100:101], v7 offset:9312
    v_mfma_f32_16x16x32_bf16 v[52:55], v[128:131], v[104:107], v[52:55]
    ds_read_b64_tr_b16 v[102:103], v8 offset:9312
    v_add_u32 v2, s66, v2
    v_mfma_f32_16x16x32_bf16 v[56:59], v[124:127], v[108:111], v[56:59]
    ds_read_b64_tr_b16 v[104:105], v7 offset:9344
    v_mfma_f32_16x16x32_bf16 v[60:63], v[128:131], v[108:111], v[60:63]
    ds_read_b64_tr_b16 v[106:107], v8 offset:9344
    v_add_u32 v3, s66, v3
    s_waitcnt lgkmcnt(12)
    v_mfma_f32_16x16x32_bf16 v[64:67], v[124:127], v[112:115], v[64:67]
    ds_read_b64_tr_b16 v[108:109], v7 offset:9376
    v_mfma_f32_16x16x32_bf16 v[68:71], v[128:131], v[112:115], v[68:71]
    ds_read_b64_tr_b16 v[110:111], v8 offset:9376
    v_mfma_f32_16x16x32_bf16 v[72:75], v[124:127], v[116:119], v[72:75]
    ds_read_b64_tr_b16 v[112:113], v7 offset:9408
    v_mfma_f32_16x16x32_bf16 v[76:79], v[128:131], v[116:119], v[76:79]
    ds_read_b64_tr_b16 v[114:115], v8 offset:9408
    v_add_u32 v4, s66, v4
    v_mfma_f32_16x16x32_bf16 v[80:83], v[124:127], v[120:123], v[80:83]
    ds_read_b64_tr_b16 v[116:117], v7 offset:9440
    v_mfma_f32_16x16x32_bf16 v[84:87], v[128:131], v[120:123], v[84:87]
    ds_read_b64_tr_b16 v[118:119], v8 offset:9440
    s_waitcnt lgkmcnt(10)
    v_mfma_f32_16x16x32_bf16 v[16:19], v[132:135], v[88:91], v[16:19]
    ds_read_b64_tr_b16 v[120:121], v7 offset:9472
    v_mfma_f32_16x16x32_bf16 v[20:23], v[136:139], v[88:91], v[20:23]
    ds_read_b64_tr_b16 v[122:123], v8 offset:9472
    s_barrier
    v_mfma_f32_16x16x32_bf16 v[24:27], v[132:135], v[92:95], v[24:27]
    ds_read_b64_tr_b16 v[88:89], v2 offset:0
    ds_read_b128 v[124:127], v4 offset:0
    v_mfma_f32_16x16x32_bf16 v[28:31], v[136:139], v[92:95], v[28:31]
    ds_read_b64_tr_b16 v[90:91], v3 offset:0
    v_mfma_f32_16x16x32_bf16 v[32:35], v[132:135], v[96:99], v[32:35]
    ds_read_b64_tr_b16 v[92:93], v2 offset:32
    v_mfma_f32_16x16x32_bf16 v[36:39], v[136:139], v[96:99], v[36:39]
    ds_read_b64_tr_b16 v[94:95], v3 offset:32
    s_waitcnt lgkmcnt(11)
    v_mfma_f32_16x16x32_bf16 v[40:43], v[132:135], v[100:103], v[40:43]
    ds_read_b64_tr_b16 v[96:97], v2 offset:64
    ds_read_b128 v[128:131], v4 offset:2048
    v_mfma_f32_16x16x32_bf16 v[44:47], v[136:139], v[100:103], v[44:47]
    ds_read_b64_tr_b16 v[98:99], v3 offset:64
    v_mfma_f32_16x16x32_bf16 v[48:51], v[132:135], v[104:107], v[48:51]
    ds_read_b64_tr_b16 v[100:101], v2 offset:96
    v_mfma_f32_16x16x32_bf16 v[52:55], v[136:139], v[104:107], v[52:55]
    ds_read_b64_tr_b16 v[102:103], v3 offset:96
    v_mov_b32 v7, v2
    v_mfma_f32_16x16x32_bf16 v[56:59], v[132:135], v[108:111], v[56:59]
    ds_read_b64_tr_b16 v[104:105], v2 offset:128
    v_mfma_f32_16x16x32_bf16 v[60:63], v[136:139], v[108:111], v[60:63]
    ds_read_b64_tr_b16 v[106:107], v3 offset:128
    v_mov_b32 v8, v3
    s_waitcnt lgkmcnt(12)
    v_mfma_f32_16x16x32_bf16 v[64:67], v[132:135], v[112:115], v[64:67]
    ds_read_b64_tr_b16 v[108:109], v2 offset:160
    v_mfma_f32_16x16x32_bf16 v[68:71], v[136:139], v[112:115], v[68:71]
    ds_read_b64_tr_b16 v[110:111], v3 offset:160
    v_mfma_f32_16x16x32_bf16 v[72:75], v[132:135], v[116:119], v[72:75]
    ds_read_b64_tr_b16 v[112:113], v2 offset:192
    v_mfma_f32_16x16x32_bf16 v[76:79], v[136:139], v[116:119], v[76:79]
    ds_read_b64_tr_b16 v[114:115], v3 offset:192
    v_xor_b32 v9, 64, v4
    s_cmp_lt_u32 s65, 9
    v_mfma_f32_16x16x32_bf16 v[80:83], v[132:135], v[120:123], v[80:83]
    ds_read_b64_tr_b16 v[116:117], v2 offset:224
    v_mfma_f32_16x16x32_bf16 v[84:87], v[136:139], v[120:123], v[84:87]
    ds_read_b64_tr_b16 v[118:119], v3 offset:224
    s_cbranch_scc1 L_kvloop
    s_setprio 3
    s_waitcnt lgkmcnt(0)
    v_pk_mul_f32 v[140:141], v[16:17], s[68:69]
    v_pk_mul_f32 v[142:143], v[18:19], s[68:69]
    v_pk_mul_f32 v[144:145], v[20:21], s[68:69]
    v_pk_mul_f32 v[146:147], v[22:23], s[68:69]
    v_exp_f32 v140, v140 clamp
    v_exp_f32 v141, v141 clamp
    v_exp_f32 v142, v142 clamp
    v_exp_f32 v143, v143 clamp
    v_exp_f32 v144, v144 clamp
    v_exp_f32 v145, v145 clamp
    v_exp_f32 v146, v146 clamp
    v_exp_f32 v147, v147 clamp
    v_max_f32 v16, s70, v16
    v_max_f32 v17, s70, v17
    v_max_f32 v18, s70, v18
    v_max_f32 v19, s70, v19
    v_max_f32 v20, s70, v20
    v_max_f32 v21, s70, v21
    v_max_f32 v22, s70, v22
    v_max_f32 v23, s70, v23
    v_pk_add_f32 v[16:17], v[16:17], v[140:141]
    v_pk_add_f32 v[18:19], v[18:19], v[142:143]
    v_pk_add_f32 v[20:21], v[20:21], v[144:145]
    v_pk_add_f32 v[22:23], v[22:23], v[146:147]
    v_cvt_pk_bf16_f32 v108, v56, v57
    v_cvt_pk_bf16_f32 v109, v58, v59
    v_cvt_pk_bf16_f32 v110, v60, v61
    v_cvt_pk_bf16_f32 v111, v62, v63
    ds_write_b128 v12, v[108:111] offset:5120
    v_cvt_pk_bf16_f32 v88, v16, v17
    v_cvt_pk_bf16_f32 v89, v18, v19
    v_cvt_pk_bf16_f32 v90, v20, v21
    v_cvt_pk_bf16_f32 v91, v22, v23
    ds_write_b128 v12, v[88:91] offset:0
    v_pk_mul_f32 v[140:141], v[24:25], s[68:69]
    v_pk_mul_f32 v[142:143], v[26:27], s[68:69]
    v_pk_mul_f32 v[144:145], v[28:29], s[68:69]
    v_pk_mul_f32 v[146:147], v[30:31], s[68:69]
    v_exp_f32 v140, v140 clamp
    v_exp_f32 v141, v141 clamp
    v_exp_f32 v142, v142 clamp
    v_exp_f32 v143, v143 clamp
    v_exp_f32 v144, v144 clamp
    v_exp_f32 v145, v145 clamp
    v_exp_f32 v146, v146 clamp
    v_exp_f32 v147, v147 clamp
    v_max_f32 v24, s70, v24
    v_max_f32 v25, s70, v25
    v_max_f32 v26, s70, v26
    v_max_f32 v27, s70, v27
    v_max_f32 v28, s70, v28
    v_max_f32 v29, s70, v29
    v_max_f32 v30, s70, v30
    v_max_f32 v31, s70, v31
    v_pk_add_f32 v[24:25], v[24:25], v[140:141]
    v_pk_add_f32 v[26:27], v[26:27], v[142:143]
    v_pk_add_f32 v[28:29], v[28:29], v[144:145]
    v_pk_add_f32 v[30:31], v[30:31], v[146:147]
    v_cvt_pk_bf16_f32 v112, v64, v65
    v_cvt_pk_bf16_f32 v113, v66, v67
    v_cvt_pk_bf16_f32 v114, v68, v69
    v_cvt_pk_bf16_f32 v115, v70, v71
    ds_write_b128 v12, v[112:115] offset:6144
    v_cvt_pk_bf16_f32 v92, v24, v25
    v_cvt_pk_bf16_f32 v93, v26, v27
    v_cvt_pk_bf16_f32 v94, v28, v29
    v_cvt_pk_bf16_f32 v95, v30, v31
    ds_write_b128 v12, v[92:95] offset:1024
    v_pk_mul_f32 v[140:141], v[32:33], s[68:69]
    v_pk_mul_f32 v[142:143], v[34:35], s[68:69]
    v_pk_mul_f32 v[144:145], v[36:37], s[68:69]
    v_pk_mul_f32 v[146:147], v[38:39], s[68:69]
    v_exp_f32 v140, v140 clamp
    v_exp_f32 v141, v141 clamp
    v_exp_f32 v142, v142 clamp
    v_exp_f32 v143, v143 clamp
    v_exp_f32 v144, v144 clamp
    v_exp_f32 v145, v145 clamp
    v_exp_f32 v146, v146 clamp
    v_exp_f32 v147, v147 clamp
    v_max_f32 v32, s70, v32
    v_max_f32 v33, s70, v33
    v_max_f32 v34, s70, v34
    v_max_f32 v35, s70, v35
    v_max_f32 v36, s70, v36
    v_max_f32 v37, s70, v37
    v_max_f32 v38, s70, v38
    v_max_f32 v39, s70, v39
    v_pk_add_f32 v[32:33], v[32:33], v[140:141]
    v_pk_add_f32 v[34:35], v[34:35], v[142:143]
    v_pk_add_f32 v[36:37], v[36:37], v[144:145]
    v_pk_add_f32 v[38:39], v[38:39], v[146:147]
    v_cvt_pk_bf16_f32 v116, v72, v73
    v_cvt_pk_bf16_f32 v117, v74, v75
    v_cvt_pk_bf16_f32 v118, v76, v77
    v_cvt_pk_bf16_f32 v119, v78, v79
    ds_write_b128 v12, v[116:119] offset:7168
    v_cvt_pk_bf16_f32 v96, v32, v33
    v_cvt_pk_bf16_f32 v97, v34, v35
    v_cvt_pk_bf16_f32 v98, v36, v37
    v_cvt_pk_bf16_f32 v99, v38, v39
    ds_write_b128 v12, v[96:99] offset:2048
    v_pk_mul_f32 v[140:141], v[40:41], s[68:69]
    v_pk_mul_f32 v[142:143], v[42:43], s[68:69]
    v_pk_mul_f32 v[144:145], v[44:45], s[68:69]
    v_pk_mul_f32 v[146:147], v[46:47], s[68:69]
    v_exp_f32 v140, v140 clamp
    v_exp_f32 v141, v141 clamp
    v_exp_f32 v142, v142 clamp
    v_exp_f32 v143, v143 clamp
    v_exp_f32 v144, v144 clamp
    v_exp_f32 v145, v145 clamp
    v_exp_f32 v146, v146 clamp
    v_exp_f32 v147, v147 clamp
    v_max_f32 v40, s70, v40
    v_max_f32 v41, s70, v41
    v_max_f32 v42, s70, v42
    v_max_f32 v43, s70, v43
    v_max_f32 v44, s70, v44
    v_max_f32 v45, s70, v45
    v_max_f32 v46, s70, v46
    v_max_f32 v47, s70, v47
    v_pk_add_f32 v[40:41], v[40:41], v[140:141]
    v_pk_add_f32 v[42:43], v[42:43], v[142:143]
    v_pk_add_f32 v[44:45], v[44:45], v[144:145]
    v_pk_add_f32 v[46:47], v[46:47], v[146:147]
    v_cvt_pk_bf16_f32 v120, v80, v81
    v_cvt_pk_bf16_f32 v121, v82, v83
    v_cvt_pk_bf16_f32 v122, v84, v85
    v_cvt_pk_bf16_f32 v123, v86, v87
    ds_write_b128 v12, v[120:123] offset:8192
    v_cvt_pk_bf16_f32 v100, v40, v41
    v_cvt_pk_bf16_f32 v101, v42, v43
    v_cvt_pk_bf16_f32 v102, v44, v45
    v_cvt_pk_bf16_f32 v103, v46, v47
    ds_write_b128 v12, v[100:103] offset:3072
    s_mov_b32 exec_lo, 0x00ff00ff
    s_mov_b32 exec_hi, 0x00ff00ff
    v_pk_mul_f32 v[140:141], v[48:49], s[68:69]
    v_pk_mul_f32 v[142:143], v[50:51], s[68:69]
    v_pk_mul_f32 v[144:145], v[52:53], s[68:69]
    v_pk_mul_f32 v[146:147], v[54:55], s[68:69]
    v_exp_f32 v140, v140 clamp
    v_exp_f32 v141, v141 clamp
    v_exp_f32 v142, v142 clamp
    v_exp_f32 v143, v143 clamp
    v_exp_f32 v144, v144 clamp
    v_exp_f32 v145, v145 clamp
    v_exp_f32 v146, v146 clamp
    v_exp_f32 v147, v147 clamp
    v_max_f32 v48, s70, v48
    v_max_f32 v49, s70, v49
    v_max_f32 v50, s70, v50
    v_max_f32 v51, s70, v51
    v_max_f32 v52, s70, v52
    v_max_f32 v53, s70, v53
    v_max_f32 v54, s70, v54
    v_max_f32 v55, s70, v55
    v_pk_add_f32 v[48:49], v[48:49], v[140:141]
    v_pk_add_f32 v[50:51], v[50:51], v[142:143]
    v_pk_add_f32 v[52:53], v[52:53], v[144:145]
    v_pk_add_f32 v[54:55], v[54:55], v[146:147]
    s_mov_b64 exec, -1
    v_cvt_pk_bf16_f32 v104, v48, v49
    v_cvt_pk_bf16_f32 v105, v50, v51
    v_cvt_pk_bf16_f32 v106, v52, v53
    v_cvt_pk_bf16_f32 v107, v54, v55
    ds_write_b128 v12, v[104:107] offset:4096
    s_mov_b64 exec, 1
    ds_add_u32 v15, v11 offset:0
    s_mov_b64 exec, -1
    s_mov_b32 s59, 0
WL1:
WI1:
    ds_read_b32 v14, v15 offset:0
    s_add_u32 s59, s59, 1
    s_waitcnt lgkmcnt(0)
    v_cmp_ne_u32 vcc, 4, v14
    s_cmp_ge_u32 s59, 524288
    s_cbranch_scc1 WX1
    s_nop 2
    s_cbranch_vccnz WL1
WX1:
    ds_read_b128 v[16:19], v148 offset:0
    ds_read_b128 v[20:23], v148 offset:4096
    ds_read_b128 v[24:27], v148 offset:1024
    ds_read_b128 v[28:31], v148 offset:5120
    ds_read_b128 v[32:35], v148 offset:9216
    ds_read_b128 v[36:39], v148 offset:13312
    ds_read_b128 v[40:43], v148 offset:10240
    ds_read_b128 v[44:47], v148 offset:14336
    ds_read_b128 v[48:51], v148 offset:18432
    ds_read_b128 v[52:55], v148 offset:22528
    ds_read_b128 v[56:59], v148 offset:19456
    ds_read_b128 v[60:63], v148 offset:23552
    ds_read_b128 v[64:67], v148 offset:27648
    ds_read_b128 v[68:71], v148 offset:31744
    ds_read_b128 v[72:75], v148 offset:28672
    ds_read_b128 v[76:79], v148 offset:32768
    s_waitcnt lgkmcnt(14)
    v_mfma_f32_16x16x32_bf16 v[100:103], v[20:23], v[16:19], 0
    v_mfma_f32_16x16x32_bf16 v[116:119], v[156:159], v[16:19], 0
    s_waitcnt lgkmcnt(12)
    v_mfma_f32_16x16x32_bf16 v[104:107], v[20:23], v[24:27], 0
    v_mfma_f32_16x16x32_bf16 v[108:111], v[28:31], v[16:19], 0
    v_mfma_f32_16x16x32_bf16 v[120:123], v[156:159], v[24:27], 0
    v_mfma_f32_16x16x32_bf16 v[112:115], v[28:31], v[24:27], 0
    s_waitcnt lgkmcnt(10)
    v_mfma_f32_16x16x32_bf16 v[100:103], v[36:39], v[32:35], v[100:103]
    v_mfma_f32_16x16x32_bf16 v[116:119], v[156:159], v[32:35], v[116:119]
    s_waitcnt lgkmcnt(8)
    v_mfma_f32_16x16x32_bf16 v[104:107], v[36:39], v[40:43], v[104:107]
    v_mfma_f32_16x16x32_bf16 v[108:111], v[44:47], v[32:35], v[108:111]
    v_mfma_f32_16x16x32_bf16 v[120:123], v[156:159], v[40:43], v[120:123]
    v_mfma_f32_16x16x32_bf16 v[112:115], v[44:47], v[40:43], v[112:115]
    s_waitcnt lgkmcnt(6)
    v_mfma_f32_16x16x32_bf16 v[100:103], v[52:55], v[48:51], v[100:103]
    v_mfma_f32_16x16x32_bf16 v[116:119], v[156:159], v[48:51], v[116:119]
    s_waitcnt lgkmcnt(4)
    v_mfma_f32_16x16x32_bf16 v[104:107], v[52:55], v[56:59], v[104:107]
    v_mfma_f32_16x16x32_bf16 v[108:111], v[60:63], v[48:51], v[108:111]
    v_mfma_f32_16x16x32_bf16 v[120:123], v[156:159], v[56:59], v[120:123]
    v_mfma_f32_16x16x32_bf16 v[112:115], v[60:63], v[56:59], v[112:115]
    s_waitcnt lgkmcnt(2)
    v_mfma_f32_16x16x32_bf16 v[100:103], v[68:71], v[64:67], v[100:103]
    v_mfma_f32_16x16x32_bf16 v[116:119], v[156:159], v[64:67], v[116:119]
    s_waitcnt lgkmcnt(0)
    v_mfma_f32_16x16x32_bf16 v[104:107], v[68:71], v[72:75], v[104:107]
    v_mfma_f32_16x16x32_bf16 v[108:111], v[76:79], v[64:67], v[108:111]
    v_mfma_f32_16x16x32_bf16 v[120:123], v[156:159], v[72:75], v[120:123]
    v_mfma_f32_16x16x32_bf16 v[112:115], v[76:79], v[72:75], v[112:115]
    s_nop 1
    ds_write_b32 v149, v100 offset:0
    ds_write_b32 v149, v101 offset:132
    ds_write_b32 v149, v102 offset:264
    ds_write_b32 v149, v103 offset:396
    s_mov_b64 exec, 0xffff
    ds_write_b32 v149, v116 offset:4224
    ds_write_b32 v149, v120 offset:4288
    s_mov_b64 exec, -1
    ds_write_b32 v149, v104 offset:64
    ds_write_b32 v149, v105 offset:196
    ds_write_b32 v149, v106 offset:328
    ds_write_b32 v149, v107 offset:460
    ds_write_b32 v149, v108 offset:2112
    ds_write_b32 v149, v109 offset:2244
    ds_write_b32 v149, v110 offset:2376
    ds_write_b32 v149, v111 offset:2508
    ds_write_b32 v149, v112 offset:2176
    ds_write_b32 v149, v113 offset:2308
    ds_write_b32 v149, v114 offset:2440
    ds_write_b32 v149, v115 offset:2572
    ds_read_b32 v16, v150
    ds_read_b32 v17, v151
    ds_read_b32 v18, v152
    ds_read_b32 v19, v153
    ds_read_b32 v20, v154
    ds_read_b32 v21, v155
    s_waitcnt lgkmcnt(5)
    buffer_atomic_add_f32 v16, v13, s[52:55], s56 offen offset:0
    s_waitcnt lgkmcnt(4)
    buffer_atomic_add_f32 v17, v13, s[52:55], s56 offen offset:256
    s_waitcnt lgkmcnt(3)
    buffer_atomic_add_f32 v18, v13, s[52:55], s56 offen offset:512
    s_waitcnt lgkmcnt(2)
    buffer_atomic_add_f32 v19, v13, s[52:55], s56 offen offset:768
    s_waitcnt lgkmcnt(1)
    buffer_atomic_add_f32 v20, v13, s[52:55], s56 offen offset:1024
    s_mov_b64 exec, 0x3fffff
    s_waitcnt lgkmcnt(0)
    buffer_atomic_add_f32 v21, v13, s[52:55], s56 offen offset:1280
    s_mov_b64 exec, 1
    s_waitcnt vmcnt(0)
    ds_add_rtn_u32 v14, v15, v11 offset:4
    s_mov_b64 exec, 0xff
    s_waitcnt lgkmcnt(0)
    v_readfirstlane_b32 s14, v14
    s_nop 1
    s_cmp_lg_u32 s14, 3
    s_cbranch_scc1 L_nosig
    buffer_atomic_add v11, v10, s[52:55], s57 offen sc1
L_nosig:
    s_mov_b64 exec, -1
    s_setprio 0
    s_branch L_s1
L_help:
    s_mov_b32 s52, s40
    s_mov_b32 s53, s41
    s_mov_b32 s54, 268435456
    s_mov_b32 s55, 0x20000
    v_lshlrev_b32 v2, 4, v0
    s_cmp_ge_u32 s3, 8
    s_cbranch_scc1 L_s2
    v_mov_b32 v15, 77312
    v_mov_b32 v11, 1
    s_cmp_lg_u32 s3, 4
    s_cbranch_scc1 L_h1
    s_mov_b64 exec, 255
    s_mov_b32 s59, 0
    s_branch PC2
PL2:
    s_sleep 32
PI2:
    buffer_load_dword v14, v13, s[76:79], 0 offen sc0 sc1
PC2:
    s_add_u32 s59, s59, 1
    s_waitcnt vmcnt(0)
    v_cmp_ne_u32 vcc, 1, v14
    s_cmp_ge_u32 s59, 32768
    s_cbranch_scc1 PX2
    s_nop 2
    s_cbranch_vccnz PL2
PX2:
    s_mov_b64 exec, -1
    v_mov_b32 v4, 0
    v_lshl_add_u32 v5, v0, 2, v15
    ds_write_b32 v5, v4
    s_lshl_b32 s57, s6, 1
    s_add_u32 s57, s57, s11
    s_lshl_b32 s57, s57, 3
    s_add_u32 s57, s57, s7
    s_mul_i32 s57, s57, 1024
    s_add_u32 s57, s57, 3473408
    s_cmp_lt_u32 s7, 5
    s_waitcnt lgkmcnt(0)
    s_barrier
    s_cbranch_scc0 L_exit
    s_mov_b32 s59, 0
    s_branch WI3
WL3:
    s_sleep 2
WI3:
    ds_read_b32 v14, v15 offset:0
    s_add_u32 s59, s59, 1
    s_waitcnt lgkmcnt(0)
    v_cmp_ne_u32 vcc, 4, v14
    s_cmp_ge_u32 s59, 524288
    s_cbranch_scc1 WX3
    s_nop 2
    s_cbranch_vccnz WL3
WX3:
    s_mov_b64 exec, 1
    s_mov_b32 s59, 0
    s_branch PI4
PL4:
    s_sleep 2
PI4:
    buffer_load_dword v14, v13, s[52:55], s57 offen sc0 sc1
PC4:
    s_add_u32 s59, s59, 1
    s_waitcnt vmcnt(0)
    v_cmp_ne_u32 vcc, 6, v14
    s_cmp_ge_u32 s59, 32768
    s_cbranch_scc1 PX4
    s_nop 2
    s_cbranch_vccnz PL4
PX4:
    s_mov_b64 exec, -1
    s_mov_b64 exec, 1
    ds_add_u32 v15, v11 offset:12
    s_mov_b64 exec, -1
    s_branch L_h2
L_h1:
    s_barrier
L_h2:
    s_mov_b32 s59, 0
    s_branch WI5
WL5:
    s_sleep 2
WI5:
    ds_read_b32 v14, v15 offset:4
    s_add_u32 s59, s59, 1
    s_waitcnt lgkmcnt(0)
    v_cmp_ne_u32 vcc, 4, v14
    s_cmp_ge_u32 s59, 524288
    s_cbranch_scc1 WX5
    s_nop 2
    s_cbranch_vccnz WL5
WX5:
L_s1:
    v_lshlrev_b32 v2, 4, v0
    s_lshr_b32 s12, s3, 1
    s_and_b32 s9, s3, 1
    s_mul_i32 s8, s12, 9
    s_lshl_b32 s14, s9, 2
    s_add_u32 s8, s8, s14
    s_lshl_b32 s15, s6, 1
    s_add_u32 s15, s15, s11
    s_mul_i32 s15, s15, 72
    s_add_u32 s15, s15, s8
    s_lshl_b32 s15, s15, 10
    s_mov_b32 s44, s15
    s_add_u32 s45, s15, 36864
    s_add_u32 s46, s15, 4096
    s_add_u32 s47, s15, 40960
    s_mov_b32 s59, 0
    s_branch WI6
WL6:
    s_sleep 1
WI6:
    ds_read_b32 v14, v15 offset:12
    s_add_u32 s59, s59, 1
    s_waitcnt lgkmcnt(0)
    v_cmp_ne_u32 vcc, 1, v14
    s_cmp_ge_u32 s59, 524288
    s_cbranch_scc1 WX6
    s_nop 2
    s_cbranch_vccnz WL6
WX6:
    buffer_load_dwordx4 v[16:19], v2, s[52:55], s44 offen offset:0 sc0 sc1
    buffer_load_dwordx4 v[36:39], v2, s[52:55], s45 offen offset:0 sc0 sc1
    buffer_load_dwordx4 v[20:23], v2, s[52:55], s44 offen offset:1024 sc0 sc1
    buffer_load_dwordx4 v[40:43], v2, s[52:55], s45 offen offset:1024 sc0 sc1
    v_lshrrev_b32 v3, 5, v0
    v_lshlrev_b32 v4, 3, v3
    s_lshl_b32 s42, s9, 3
    v_subrev_u32 v4, s42, v4
    v_add_u32 v5, -6, v4
    v_cmp_gt_u32 s[60:61], 18, v5
    v_add_u32 v5, -4, v4
    v_cmp_gt_u32 s[62:63], 18, v5
    v_add_u32 v5, -2, v4
    v_cmp_gt_u32 s[64:65], 18, v5
    v_add_u32 v5, 0, v4
    v_cmp_gt_u32 s[66:67], 18, v5
    v_add_u32 v5, 2, v4
    v_cmp_gt_u32 s[68:69], 18, v5
    v_add_u32 v5, 4, v4
    v_cmp_gt_u32 s[70:71], 18, v5
    v_add_u32 v5, 6, v4
    v_cmp_gt_u32 s[72:73], 18, v5
    v_add_u32 v5, 8, v4
    v_cmp_gt_u32 s[74:75], 18, v5
    v_add_u32 v5, 10, v4
    v_cmp_gt_u32 s[76:77], 18, v5
    v_add_u32 v5, 12, v4
    v_cmp_gt_u32 s[78:79], 18, v5
    v_add_u32 v5, 14, v4
    v_cmp_gt_u32 s[80:81], 18, v5
    v_add_u32 v5, 16, v4
    v_cmp_gt_u32 s[82:83], 18, v5
    v_add_u32 v5, 18, v4
    v_cmp_gt_u32 s[84:85], 18, v5
    v_add_u32 v5, 20, v4
    v_cmp_gt_u32 s[86:87], 18, v5
    v_add_u32 v5, 22, v4
    v_cmp_gt_u32 s[88:89], 18, v5
    s_lshl_b32 s13, s3, 11
    s_mul_i32 s56, s3, 5632
    s_add_u32 s56, s56, 78848
    v_and_b32 v5, 31, v0
    v_min_u32 v6, 18, v5
    v_cmp_eq_u32 vcc, 17, v5
    s_nop 1
    v_cndmask_b32 v6, v6, 18, vcc
    v_cmp_eq_u32 vcc, 20, v5
    s_nop 1
    v_cndmask_b32 v6, v6, 17, vcc
    v_mul_u32_u24 v6, 72, v6
    v_lshl_add_u32 v6, v4, 2, v6
    v_add_u32 v6, s56, v6
    v_add_u32 v7, s13, v2
    s_lshl_b32 s14, s12, 11
    s_add_u32 s14, s14, 65536
    s_add_u32 s14, s14, s42
    v_add_u32 v8, s14, v2
    s_mov_b32 s43, 0x358637bd
    s_mov_b32 s59, 0
WL7:
WI7:
    ds_read_b32 v14, v15 offset:4
    s_add_u32 s59, s59, 1
    s_waitcnt lgkmcnt(0)
    v_cmp_ne_u32 vcc, 4, v14
    s_cmp_ge_u32 s59, 524288
    s_cbranch_scc1 WX7
    s_nop 2
    s_cbranch_vccnz WL7
WX7:
    s_lshl_b32 s14, s12, 2
    v_add_u32 v15, s14, v15
    s_mov_b32 s59, 0
WL8:
WI8:
    ds_read_b32 v14, v15 offset:16
    s_add_u32 s59, s59, 1
    s_waitcnt lgkmcnt(0)
    v_cmp_gt_u32 vcc, 1, v14
    s_cmp_ge_u32 s59, 524288
    s_cbranch_scc1 WX8
    s_nop 2
    s_cbranch_vccnz WL8
WX8:
    buffer_load_dwordx4 v[24:27], v2, s[52:55], s44 offen offset:2048 sc0 sc1
    buffer_load_dwordx4 v[44:47], v2, s[52:55], s45 offen offset:2048 sc0 sc1
    buffer_load_dwordx4 v[28:31], v2, s[52:55], s44 offen offset:3072 sc0 sc1
    buffer_load_dwordx4 v[48:51], v2, s[52:55], s45 offen offset:3072 sc0 sc1
    buffer_load_dwordx4 v[32:35], v2, s[52:55], s46 offen offset:0 sc0 sc1
    buffer_load_dwordx4 v[52:55], v2, s[52:55], s47 offen offset:0 sc0 sc1
    s_mov_b32 s59, 0
WL9:
WI9:
    ds_read_b32 v14, v15 offset:16
    s_add_u32 s59, s59, 1
    s_waitcnt lgkmcnt(0)
    v_cmp_ne_u32 vcc, 2, v14
    s_cmp_ge_u32 s59, 524288
    s_cbranch_scc1 WX9
    s_nop 2
    s_cbranch_vccnz WL9
WX9:
    v_mov_b32 v15, 77312
    s_setprio 3
    ds_read_b64 v[88:89], v6 offset:0
    ds_read_b64 v[90:91], v6 offset:8
    ds_read_b64 v[92:93], v6 offset:16
    ds_read_b64 v[94:95], v6 offset:24
    ds_read_b64 v[96:97], v6 offset:64
    ds_read_b64 v[98:99], v6 offset:72
    ds_read_b64 v[100:101], v6 offset:80
    ds_read_b64 v[102:103], v6 offset:88
    s_waitcnt lgkmcnt(4)
    v_cvt_pk_bf16_f32 v56, v88, v89
    v_cvt_pk_bf16_f32 v57, v90, v91
    v_cvt_pk_bf16_f32 v58, v92, v93
    v_cvt_pk_bf16_f32 v59, v94, v95
    v_cndmask_b32 v56, 0, v56, s[66:67]
    v_cndmask_b32 v57, 0, v57, s[68:69]
    v_cndmask_b32 v58, 0, v58, s[70:71]
    v_cndmask_b32 v59, 0, v59, s[72:73]
    s_waitcnt lgkmcnt(0)
    v_cvt_pk_bf16_f32 v60, v96, v97
    v_cvt_pk_bf16_f32 v61, v98, v99
    v_cvt_pk_bf16_f32 v62, v100, v101
    v_cvt_pk_bf16_f32 v63, v102, v103
    v_cndmask_b32 v60, 0, v60, s[82:83]
    v_cndmask_b32 v61, 0, v61, s[84:85]
    v_cndmask_b32 v62, 0, v62, s[86:87]
    v_cndmask_b32 v63, 0, v63, s[88:89]
    s_waitcnt vmcnt(6)
    v_mfma_f32_32x32x16_bf16 v[120:135], v[56:59], v[16:19], 0
    v_mfma_f32_32x32x16_bf16 v[120:135], v[60:63], v[20:23], v[120:135]
    v_mfma_f32_32x32x16_bf16 v[136:151], v[56:59], v[36:39], 0
    v_mfma_f32_32x32x16_bf16 v[136:151], v[60:63], v[40:43], v[136:151]
    ds_read_b64 v[104:105], v6 offset:1400
    ds_read_b64 v[106:107], v6 offset:1408
    ds_read_b64 v[108:109], v6 offset:1416
    ds_read_b64 v[110:111], v6 offset:1424
    ds_read_b64 v[112:113], v6 offset:1464
    ds_read_b64 v[114:115], v6 offset:1472
    ds_read_b64 v[116:117], v6 offset:1480
    ds_read_b64 v[118:119], v6 offset:1488
    ds_read_b64 v[88:89], v6 offset:2800
    ds_read_b64 v[90:91], v6 offset:2808
    ds_read_b64 v[92:93], v6 offset:2816
    ds_read_b64 v[94:95], v6 offset:2824
    ds_read_b64 v[96:97], v6 offset:2864
    ds_read_b64 v[98:99], v6 offset:2872
    ds_read_b64 v[100:101], v6 offset:2880
    ds_read_b64 v[102:103], v6 offset:2888
    v_add_f32 v130, s43, v129
    v_rcp_f32 v130, v130
    s_nop 0
    v_pk_mul_f32 v[120:121], v[120:121], v[130:131] op_sel_hi:[1,0]
    v_pk_mul_f32 v[122:123], v[122:123], v[130:131] op_sel_hi:[1,0]
    v_pk_mul_f32 v[124:125], v[124:125], v[130:131] op_sel_hi:[1,0]
    v_pk_mul_f32 v[126:127], v[126:127], v[130:131] op_sel_hi:[1,0]
    v_mul_f32 v152, v128, v130
    v_cvt_pk_bf16_f32 v132, v120, v121
    v_cvt_pk_bf16_f32 v133, v122, v123
    v_cvt_pk_bf16_f32 v134, v124, v125
    v_cvt_pk_bf16_f32 v135, v126, v127
    ds_write_b128 v7, v[132:135] offset:0
    v_add_f32 v146, s43, v145
    v_rcp_f32 v146, v146
    s_nop 0
    v_pk_mul_f32 v[136:137], v[136:137], v[146:147] op_sel_hi:[1,0]
    v_pk_mul_f32 v[138:139], v[138:139], v[146:147] op_sel_hi:[1,0]
    v_pk_mul_f32 v[140:141], v[140:141], v[146:147] op_sel_hi:[1,0]
    v_pk_mul_f32 v[142:143], v[142:143], v[146:147] op_sel_hi:[1,0]
    v_mul_f32 v156, v144, v146
    v_cvt_pk_bf16_f32 v148, v136, v137
    v_cvt_pk_bf16_f32 v149, v138, v139
    v_cvt_pk_bf16_f32 v150, v140, v141
    v_cvt_pk_bf16_f32 v151, v142, v143
    ds_write_b128 v7, v[148:151] offset:1024
    s_mov_b64 exec, 1
    ds_add_u32 v15, v11 offset:32
    s_mov_b64 exec, -1
    s_setprio 2
    s_waitcnt lgkmcnt(3)
    v_cvt_pk_bf16_f32 v64, v104, v105
    v_cvt_pk_bf16_f32 v65, v106, v107
    v_cvt_pk_bf16_f32 v66, v108, v109
    v_cvt_pk_bf16_f32 v67, v110, v111
    v_cndmask_b32 v64, 0, v64, s[64:65]
    v_cndmask_b32 v65, 0, v65, s[66:67]
    v_cndmask_b32 v66, 0, v66, s[68:69]
    v_cndmask_b32 v67, 0, v67, s[70:71]
    v_cvt_pk_bf16_f32 v68, v112, v113
    v_cvt_pk_bf16_f32 v69, v114, v115
    v_cvt_pk_bf16_f32 v70, v116, v117
    v_cvt_pk_bf16_f32 v71, v118, v119
    v_cndmask_b32 v68, 0, v68, s[80:81]
    v_cndmask_b32 v69, 0, v69, s[82:83]
    v_cndmask_b32 v70, 0, v70, s[84:85]
    v_cndmask_b32 v71, 0, v71, s[86:87]
    ds_read_b64 v[104:105], v6 offset:4200
    ds_read_b64 v[106:107], v6 offset:4208
    ds_read_b64 v[108:109], v6 offset:4216
    ds_read_b64 v[110:111], v6 offset:4224
    ds_read_b64 v[112:113], v6 offset:4264
    ds_read_b64 v[114:115], v6 offset:4272
    ds_read_b64 v[116:117], v6 offset:4280
    ds_read_b64 v[118:119], v6 offset:4288
    s_waitcnt vmcnt(4)
    v_mfma_f32_32x32x16_bf16 v[120:135], v[64:67], v[20:23], 0
    v_mfma_f32_32x32x16_bf16 v[120:135], v[68:71], v[24:27], v[120:135]
    v_mfma_f32_32x32x16_bf16 v[136:151], v[64:67], v[40:43], 0
    v_mfma_f32_32x32x16_bf16 v[136:151], v[68:71], v[44:47], v[136:151]
    v_cvt_pk_bf16_f32 v72, v88, v89
    v_cvt_pk_bf16_f32 v73, v90, v91
    v_cvt_pk_bf16_f32 v74, v92, v93
    v_cvt_pk_bf16_f32 v75, v94, v95
    v_cndmask_b32 v72, 0, v72, s[62:63]
    v_cndmask_b32 v73, 0, v73, s[64:65]
    v_cndmask_b32 v74, 0, v74, s[66:67]
    v_cndmask_b32 v75, 0, v75, s[68:69]
    v_cvt_pk_bf16_f32 v76, v96, v97
    v_cvt_pk_bf16_f32 v77, v98, v99
    v_cvt_pk_bf16_f32 v78, v100, v101
    v_cvt_pk_bf16_f32 v79, v102, v103
    v_cndmask_b32 v76, 0, v76, s[78:79]
    v_cndmask_b32 v77, 0, v77, s[80:81]
    v_cndmask_b32 v78, 0, v78, s[82:83]
    v_cndmask_b32 v79, 0, v79, s[84:85]
    s_waitcnt lgkmcnt(0)
    v_cvt_pk_bf16_f32 v80, v104, v105
    v_cvt_pk_bf16_f32 v81, v106, v107
    v_cvt_pk_bf16_f32 v82, v108, v109
    v_cvt_pk_bf16_f32 v83, v110, v111
    v_cndmask_b32 v80, 0, v80, s[60:61]
    v_cndmask_b32 v81, 0, v81, s[62:63]
    v_cndmask_b32 v82, 0, v82, s[64:65]
    v_cndmask_b32 v83, 0, v83, s[66:67]
    v_cvt_pk_bf16_f32 v84, v112, v113
    v_cvt_pk_bf16_f32 v85, v114, v115
    v_cvt_pk_bf16_f32 v86, v116, v117
    v_cvt_pk_bf16_f32 v87, v118, v119
    v_cndmask_b32 v84, 0, v84, s[76:77]
    v_cndmask_b32 v85, 0, v85, s[78:79]
    v_cndmask_b32 v86, 0, v86, s[80:81]
    v_cndmask_b32 v87, 0, v87, s[82:83]
    s_waitcnt vmcnt(2)
    v_mfma_f32_32x32x16_bf16 v[88:103], v[72:75], v[24:27], 0
    v_mfma_f32_32x32x16_bf16 v[88:103], v[76:79], v[28:31], v[88:103]
    v_add_f32 v130, s43, v129
    v_rcp_f32 v130, v130
    s_nop 0
    v_pk_mul_f32 v[120:121], v[120:121], v[130:131] op_sel_hi:[1,0]
    v_pk_mul_f32 v[122:123], v[122:123], v[130:131] op_sel_hi:[1,0]
    v_pk_mul_f32 v[124:125], v[124:125], v[130:131] op_sel_hi:[1,0]
    v_pk_mul_f32 v[126:127], v[126:127], v[130:131] op_sel_hi:[1,0]
    v_mul_f32 v153, v128, v130
    v_cvt_pk_bf16_f32 v132, v120, v121
    v_cvt_pk_bf16_f32 v133, v122, v123
    v_cvt_pk_bf16_f32 v134, v124, v125
    v_cvt_pk_bf16_f32 v135, v126, v127
    ds_write_b128 v7, v[132:135] offset:16384
    v_mfma_f32_32x32x16_bf16 v[104:119], v[72:75], v[44:47], 0
    v_mfma_f32_32x32x16_bf16 v[104:119], v[76:79], v[48:51], v[104:119]
    v_add_f32 v146, s43, v145
    v_rcp_f32 v146, v146
    s_nop 0
    v_pk_mul_f32 v[136:137], v[136:137], v[146:147] op_sel_hi:[1,0]
    v_pk_mul_f32 v[138:139], v[138:139], v[146:147] op_sel_hi:[1,0]
    v_pk_mul_f32 v[140:141], v[140:141], v[146:147] op_sel_hi:[1,0]
    v_pk_mul_f32 v[142:143], v[142:143], v[146:147] op_sel_hi:[1,0]
    v_mul_f32 v157, v144, v146
    v_cvt_pk_bf16_f32 v148, v136, v137
    v_cvt_pk_bf16_f32 v149, v138, v139
    v_cvt_pk_bf16_f32 v150, v140, v141
    v_cvt_pk_bf16_f32 v151, v142, v143
    ds_write_b128 v7, v[148:151] offset:17408
    s_mov_b64 exec, 1
    ds_add_u32 v15, v11 offset:36
    s_mov_b64 exec, -1
    s_setprio 1
    s_waitcnt vmcnt(0)
    v_mfma_f32_32x32x16_bf16 v[120:135], v[80:83], v[28:31], 0
    v_mfma_f32_32x32x16_bf16 v[120:135], v[84:87], v[32:35], v[120:135]
    v_add_f32 v98, s43, v97
    v_rcp_f32 v98, v98
    s_nop 0
    v_pk_mul_f32 v[88:89], v[88:89], v[98:99] op_sel_hi:[1,0]
    v_pk_mul_f32 v[90:91], v[90:91], v[98:99] op_sel_hi:[1,0]
    v_pk_mul_f32 v[92:93], v[92:93], v[98:99] op_sel_hi:[1,0]
    v_pk_mul_f32 v[94:95], v[94:95], v[98:99] op_sel_hi:[1,0]
    v_mul_f32 v154, v96, v98
    v_cvt_pk_bf16_f32 v100, v88, v89
    v_cvt_pk_bf16_f32 v101, v90, v91
    v_cvt_pk_bf16_f32 v102, v92, v93
    v_cvt_pk_bf16_f32 v103, v94, v95
    ds_write_b128 v7, v[100:103] offset:32768
    v_mfma_f32_32x32x16_bf16 v[136:151], v[80:83], v[48:51], 0
    v_mfma_f32_32x32x16_bf16 v[136:151], v[84:87], v[52:55], v[136:151]
    v_add_f32 v114, s43, v113
    v_rcp_f32 v114, v114
    s_nop 0
    v_pk_mul_f32 v[104:105], v[104:105], v[114:115] op_sel_hi:[1,0]
    v_pk_mul_f32 v[106:107], v[106:107], v[114:115] op_sel_hi:[1,0]
    v_pk_mul_f32 v[108:109], v[108:109], v[114:115] op_sel_hi:[1,0]
    v_pk_mul_f32 v[110:111], v[110:111], v[114:115] op_sel_hi:[1,0]
    v_mul_f32 v158, v112, v114
    v_cvt_pk_bf16_f32 v116, v104, v105
    v_cvt_pk_bf16_f32 v117, v106, v107
    v_cvt_pk_bf16_f32 v118, v108, v109
    v_cvt_pk_bf16_f32 v119, v110, v111
    ds_write_b128 v7, v[116:119] offset:33792
    s_mov_b64 exec, 1
    ds_add_u32 v15, v11 offset:40
    s_mov_b64 exec, -1
    s_setprio 0
    v_add_f32 v130, s43, v129
    v_rcp_f32 v130, v130
    s_nop 0
    v_pk_mul_f32 v[120:121], v[120:121], v[130:131] op_sel_hi:[1,0]
    v_pk_mul_f32 v[122:123], v[122:123], v[130:131] op_sel_hi:[1,0]
    v_pk_mul_f32 v[124:125], v[124:125], v[130:131] op_sel_hi:[1,0]
    v_pk_mul_f32 v[126:127], v[126:127], v[130:131] op_sel_hi:[1,0]
    v_mul_f32 v155, v128, v130
    v_cvt_pk_bf16_f32 v132, v120, v121
    v_cvt_pk_bf16_f32 v133, v122, v123
    v_cvt_pk_bf16_f32 v134, v124, v125
    v_cvt_pk_bf16_f32 v135, v126, v127
    ds_write_b128 v7, v[132:135] offset:49152
    v_add_f32 v146, s43, v145
    v_rcp_f32 v146, v146
    s_nop 0
    v_pk_mul_f32 v[136:137], v[136:137], v[146:147] op_sel_hi:[1,0]
    v_pk_mul_f32 v[138:139], v[138:139], v[146:147] op_sel_hi:[1,0]
    v_pk_mul_f32 v[140:141], v[140:141], v[146:147] op_sel_hi:[1,0]
    v_pk_mul_f32 v[142:143], v[142:143], v[146:147] op_sel_hi:[1,0]
    v_mul_f32 v159, v144, v146
    v_cvt_pk_bf16_f32 v148, v136, v137
    v_cvt_pk_bf16_f32 v149, v138, v139
    v_cvt_pk_bf16_f32 v150, v140, v141
    v_cvt_pk_bf16_f32 v151, v142, v143
    ds_write_b128 v7, v[148:151] offset:50176
    v_cvt_pk_bf16_f32 v160, v152, v153
    v_cvt_pk_bf16_f32 v161, v154, v155
    ds_write_b64 v8, v[160:161] offset:0
    v_cvt_pk_bf16_f32 v162, v156, v157
    v_cvt_pk_bf16_f32 v163, v158, v159
    ds_write_b64 v8, v[162:163] offset:1024
    s_mov_b64 exec, 1
    ds_add_u32 v15, v11 offset:44
    s_mov_b64 exec, -1
    s_endpgm
L_s2:
    s_sub_u32 s8, s3, 8
    s_lshl_b32 s14, s7, 2
    s_min_u32 s14, s14, 14
    s_add_u32 s14, s14, s8
    s_lshl_b32 s56, s14, 6
    s_mul_i32 s14, s14, 36864
    s_add_u32 s14, s14, 2555904
    v_mov_b32 v15, 77312
    v_mov_b32 v11, 1
    s_cmp_lg_u32 s3, 8
    s_cbranch_scc1 L_s2w
    s_mov_b64 exec, 255
    s_mov_b32 s59, 0
    s_branch PC10
PL10:
    s_sleep 32
PI10:
    buffer_load_dword v14, v13, s[76:79], 0 offen sc0 sc1
PC10:
    s_add_u32 s59, s59, 1
    s_waitcnt vmcnt(0)
    v_cmp_ne_u32 vcc, 1, v14
    s_cmp_ge_u32 s59, 32768
    s_cbranch_scc1 PX10
    s_nop 2
    s_cbranch_vccnz PL10
PX10:
    s_mov_b64 exec, -1
    s_and_b32 s57, s2, 31
    s_mul_i32 s57, s57, 1024
    s_add_u32 s57, s57, 3407872
    s_mov_b64 exec, 1
    buffer_load_dword v14, v13, s[52:55], s57 offen sc0 sc1
    s_barrier
    s_mov_b64 exec, 1
    s_mov_b32 s59, 0
    s_branch PC11
PL11:
    s_sleep 4
PI11:
    buffer_load_dword v14, v13, s[52:55], s57 offen sc0 sc1
PC11:
    s_add_u32 s59, s59, 1
    s_waitcnt vmcnt(0)
    v_cmp_ne_u32 vcc, 8, v14
    s_cmp_ge_u32 s59, 32768
    s_cbranch_scc1 PX11
    s_nop 2
    s_cbranch_vccnz PL11
PX11:
    s_mov_b64 exec, -1
    s_mov_b64 exec, 1
    ds_add_u32 v15, v11 offset:8
    s_mov_b64 exec, -1
    s_branch L_s2g
L_s2w:
    s_barrier
    s_mov_b32 s59, 0
    s_branch WI12
WL12:
    s_sleep 2
WI12:
    ds_read_b32 v14, v15 offset:8
    s_add_u32 s59, s59, 1
    s_waitcnt lgkmcnt(0)
    v_cmp_ne_u32 vcc, 1, v14
    s_cmp_ge_u32 s59, 524288
    s_cbranch_scc1 WX12
    s_nop 2
    s_cbranch_vccnz WL12
WX12:
L_s2g:
    s_lshl_b32 s64, s13, 1
    s_cmp_lt_u32 s8, s64
    s_cselect_b32 s64, 1, 0
    s_cbranch_scc1 L_s2n
    s_add_u32 s15, s14, 0
    buffer_load_dwordx4 v[72:75], v2, s[52:55], s15 offen sc0 sc1
    s_add_u32 s15, s14, 4096
    buffer_load_dwordx4 v[76:79], v2, s[52:55], s15 offen sc0 sc1
    s_add_u32 s15, s14, 9216
    buffer_load_dwordx4 v[80:83], v2, s[52:55], s15 offen sc0 sc1
    s_add_u32 s15, s14, 13312
    buffer_load_dwordx4 v[84:87], v2, s[52:55], s15 offen sc0 sc1
    s_add_u32 s15, s14, 18432
    buffer_load_dwordx4 v[88:91], v2, s[52:55], s15 offen sc0 sc1
    s_add_u32 s15, s14, 22528
    buffer_load_dwordx4 v[92:95], v2, s[52:55], s15 offen sc0 sc1
    s_add_u32 s15, s14, 27648
    buffer_load_dwordx4 v[96:99], v2, s[52:55], s15 offen sc0 sc1
    s_add_u32 s15, s14, 31744
    buffer_load_dwordx4 v[100:103], v2, s[52:55], s15 offen sc0 sc1
    s_add_u32 s15, s14, 1024
    buffer_load_dwordx4 v[104:107], v2, s[52:55], s15 offen sc0 sc1
    s_add_u32 s15, s14, 5120
    buffer_load_dwordx4 v[108:111], v2, s[52:55], s15 offen sc0 sc1
    s_add_u32 s15, s14, 10240
    buffer_load_dwordx4 v[112:115], v2, s[52:55], s15 offen sc0 sc1
    s_add_u32 s15, s14, 14336
    buffer_load_dwordx4 v[116:119], v2, s[52:55], s15 offen sc0 sc1
L_s2n:
    v_add_u32 v9, 0x10000, v2
    s_mov_b32 s44, s36
    s_mov_b32 s45, s37
    s_mov_b32 s46, 4718592
    s_mov_b32 s47, 0x20000
    v_lshrrev_b32 v5, 2, v0
    v_and_b32 v6, 3, v0
    s_mul_i32 s15, s8, 5120
    s_add_u32 s15, s15, 126976
    v_and_b32 v7, 31, v0
    v_mul_u32_u24 v12, 80, v7
    v_lshrrev_b32 v7, 5, v0
    v_lshl_add_u32 v12, v7, 5, v12
    v_add_u32 v12, s15, v12
    v_mul_u32_u24 v13, 80, v5
    v_lshl_add_u32 v13, v6, 4, v13
    v_add_u32 v13, s15, v13
    v_mul_u32_u24 v14, 2304, v5
    v_lshl_add_u32 v14, v6, 4, v14
    s_lshl_b32 s12, s6, 1
    s_add_u32 s12, s12, s11
    s_mul_i32 s12, s12, 147456
    s_add_u32 s12, s12, s56
    s_add_u32 s12, s12, 1152
    v_mul_u32_u24 v3, 1024, v0
    s_and_b32 s60, s2, 7
    s_mul_i32 s60, s60, 8192
    s_mul_i32 s61, s8, 2048
    s_add_u32 s60, s60, s61
    s_add_u32 s60, s60, 3276800
    s_mul_i32 s61, s8, 11264
    s_add_u32 s62, s61, 78848
    s_add_u32 s61, s61, 2359296
    v_mov_b32 v10, v14
    s_mov_b32 s59, 0
    s_branch WI13
WL13:
    s_sleep 2
WI13:
    ds_read_b32 v14, v15 offset:4
    s_add_u32 s59, s59, 1
    s_waitcnt lgkmcnt(0)
    v_cmp_ne_u32 vcc, 4, v14
    s_cmp_ge_u32 s59, 524288
    s_cbranch_scc1 WX13
    s_nop 2
    s_cbranch_vccnz WL13
WX13:
    s_mov_b64 exec, 3
    s_mov_b32 s59, 0
    s_branch PI14
PL14:
    s_sleep 3
PI14:
    buffer_load_dword v4, v3, s[52:55], s60 offen sc0 sc1
PC14:
    s_add_u32 s59, s59, 1
    s_waitcnt vmcnt(0)
    v_cmp_ne_u32 vcc, 16, v4
    s_cmp_ge_u32 s59, 32768
    s_cbranch_scc1 PX14
    s_nop 2
    s_cbranch_vccnz PL14
PX14:
    s_mov_b64 exec, -1
    s_add_u32 m0, s62, 0
    s_add_u32 s63, s61, 0
    buffer_load_dwordx4 v2, s[52:55], s63 offen offset:0 sc0 sc1 lds
    buffer_load_dwordx4 v2, s[52:55], s63 offen offset:1024 sc0 sc1 lds
    buffer_load_dwordx4 v2, s[52:55], s63 offen offset:2048 sc0 sc1 lds
    buffer_load_dwordx4 v2, s[52:55], s63 offen offset:3072 sc0 sc1 lds
    s_add_u32 m0, s62, 4096
    s_add_u32 s63, s61, 4096
    buffer_load_dwordx4 v2, s[52:55], s63 offen offset:0 sc0 sc1 lds
    buffer_load_dwordx4 v2, s[52:55], s63 offen offset:1024 sc0 sc1 lds
    buffer_load_dwordx4 v2, s[52:55], s63 offen offset:2048 sc0 sc1 lds
    buffer_load_dwordx4 v2, s[52:55], s63 offen offset:3072 sc0 sc1 lds
    s_add_u32 m0, s62, 8192
    s_add_u32 s63, s61, 8192
    buffer_load_dwordx4 v2, s[52:55], s63 offen offset:0 sc0 sc1 lds
    buffer_load_dwordx4 v2, s[52:55], s63 offen offset:1024 sc0 sc1 lds
    buffer_load_dwordx4 v2, s[52:55], s63 offen offset:2048 sc0 sc1 lds
    s_lshl_b32 s63, s8, 2
    v_add_u32 v15, s63, v15
    s_mov_b64 exec, 1
    ds_add_u32 v15, v11 offset:16
    s_mov_b64 exec, -1
    s_waitcnt vmcnt(0)
    s_mov_b64 exec, 1
    ds_add_u32 v15, v11 offset:16
    s_mov_b64 exec, -1
    s_cmp_lg_u32 s64, 0
    s_cbranch_scc1 L_exit
    v_mov_b32 v15, 77312
    s_mov_b32 s59, 0
WL15:
WI15:
    ds_read_b32 v14, v15 offset:32
    s_add_u32 s59, s59, 1
    s_waitcnt lgkmcnt(0)
    v_cmp_ne_u32 vcc, 8, v14
    s_cmp_ge_u32 s59, 524288
    s_cbranch_scc1 WX15
    s_nop 2
    s_cbranch_vccnz WL15
WX15:
    ds_read_b128 v[48:51], v2 offset:0
    ds_read_b128 v[52:55], v2 offset:1024
    ds_read_b128 v[56:59], v2 offset:2048
    ds_read_b128 v[60:63], v2 offset:3072
    ds_read_b128 v[64:67], v2 offset:4096
    ds_read_b128 v[68:71], v2 offset:5120
    s_waitcnt lgkmcnt(4)
    v_mfma_f32_32x32x16_bf16 v[16:31], v[72:75], v[48:51], 0
    ds_read_b128 v[48:51], v2 offset:6144
    s_add_u32 s15, s14, 19456
    buffer_load_dwordx4 v[120:123], v2, s[52:55], s15 offen sc0 sc1
    v_mfma_f32_32x32x16_bf16 v[32:47], v[72:75], v[52:55], 0
    ds_read_b128 v[52:55], v2 offset:7168
    s_add_u32 s15, s14, 23552
    buffer_load_dwordx4 v[124:127], v2, s[52:55], s15 offen sc0 sc1
    s_waitcnt lgkmcnt(4)
    v_mfma_f32_32x32x16_bf16 v[16:31], v[76:79], v[56:59], v[16:31]
    ds_read_b128 v[56:59], v2 offset:8192
    s_add_u32 s15, s14, 28672
    buffer_load_dwordx4 v[128:131], v2, s[52:55], s15 offen sc0 sc1
    v_mfma_f32_32x32x16_bf16 v[32:47], v[76:79], v[60:63], v[32:47]
    ds_read_b128 v[60:63], v2 offset:9216
    s_add_u32 s15, s14, 32768
    buffer_load_dwordx4 v[132:135], v2, s[52:55], s15 offen sc0 sc1
    s_waitcnt lgkmcnt(4)
    v_mfma_f32_32x32x16_bf16 v[16:31], v[80:83], v[64:67], v[16:31]
    ds_read_b128 v[64:67], v2 offset:10240
    s_add_u32 s15, s14, 2048
    buffer_load_dwordx4 v[136:139], v2, s[52:55], s15 offen sc0 sc1
    v_mfma_f32_32x32x16_bf16 v[32:47], v[80:83], v[68:71], v[32:47]
    ds_read_b128 v[68:71], v2 offset:11264
    s_add_u32 s15, s14, 6144
    buffer_load_dwordx4 v[140:143], v2, s[52:55], s15 offen sc0 sc1
    s_waitcnt lgkmcnt(4)
    v_mfma_f32_32x32x16_bf16 v[16:31], v[84:87], v[48:51], v[16:31]
    ds_read_b128 v[48:51], v2 offset:12288
    s_add_u32 s15, s14, 11264
    buffer_load_dwordx4 v[144:147], v2, s[52:55], s15 offen sc0 sc1
    v_mfma_f32_32x32x16_bf16 v[32:47], v[84:87], v[52:55], v[32:47]
    ds_read_b128 v[52:55], v2 offset:13312
    s_add_u32 s15, s14, 15360
    buffer_load_dwordx4 v[148:151], v2, s[52:55], s15 offen sc0 sc1
    s_waitcnt lgkmcnt(4)
    v_mfma_f32_32x32x16_bf16 v[16:31], v[88:91], v[56:59], v[16:31]
    ds_read_b32 v14, v15 offset:36
    ds_read_b128 v[56:59], v2 offset:14336
    s_add_u32 s15, s14, 20480
    buffer_load_dwordx4 v[152:155], v2, s[52:55], s15 offen sc0 sc1
    v_mfma_f32_32x32x16_bf16 v[32:47], v[88:91], v[60:63], v[32:47]
    ds_read_b128 v[60:63], v2 offset:15360
    s_add_u32 s15, s14, 24576
    buffer_load_dwordx4 v[156:159], v2, s[52:55], s15 offen sc0 sc1
    s_waitcnt lgkmcnt(5)
    v_mfma_f32_32x32x16_bf16 v[16:31], v[92:95], v[64:67], v[16:31]
    s_add_u32 s15, s14, 29696
    buffer_load_dwordx4 v[160:163], v2, s[52:55], s15 offen sc0 sc1
    v_mfma_f32_32x32x16_bf16 v[32:47], v[92:95], v[68:71], v[32:47]
    s_waitcnt lgkmcnt(2)
    v_cmp_ne_u32 vcc, 8, v14
    s_nop 4
    s_cbranch_vccz L_cok1
    s_mov_b32 s59, 0
WL16:
WI16:
    ds_read_b32 v14, v15 offset:36
    s_add_u32 s59, s59, 1
    s_waitcnt lgkmcnt(0)
    v_cmp_ne_u32 vcc, 8, v14
    s_cmp_ge_u32 s59, 524288
    s_cbranch_scc1 WX16
    s_nop 2
    s_cbranch_vccnz WL16
WX16:
L_cok1:
    ds_read_b128 v[64:67], v2 offset:16384
    s_add_u32 s15, s14, 33792
    buffer_load_dwordx4 v[164:167], v2, s[52:55], s15 offen sc0 sc1
    v_mfma_f32_32x32x16_bf16 v[16:31], v[96:99], v[48:51], v[16:31]
    ds_read_b128 v[68:71], v2 offset:17408
    s_add_u32 s15, s14, 3072
    buffer_load_dwordx4 v[72:75], v2, s[52:55], s15 offen sc0 sc1
    v_mfma_f32_32x32x16_bf16 v[32:47], v[96:99], v[52:55], v[32:47]
    ds_read_b128 v[48:51], v2 offset:18432
    s_add_u32 s15, s14, 7168
    buffer_load_dwordx4 v[76:79], v2, s[52:55], s15 offen sc0 sc1
    s_waitcnt lgkmcnt(3)
    v_mfma_f32_32x32x16_bf16 v[16:31], v[100:103], v[56:59], v[16:31]
    ds_read_b128 v[52:55], v2 offset:19456
    s_add_u32 s15, s14, 12288
    buffer_load_dwordx4 v[80:83], v2, s[52:55], s15 offen sc0 sc1
    v_mfma_f32_32x32x16_bf16 v[32:47], v[100:103], v[60:63], v[32:47]
    ds_read_b128 v[56:59], v2 offset:20480
    s_add_u32 s15, s14, 16384
    buffer_load_dwordx4 v[84:87], v2, s[52:55], s15 offen sc0 sc1
    s_waitcnt lgkmcnt(3)
    v_mfma_f32_32x32x16_bf16 v[16:31], v[104:107], v[64:67], v[16:31]
    ds_read_b128 v[60:63], v2 offset:21504
    s_add_u32 s15, s14, 21504
    buffer_load_dwordx4 v[88:91], v2, s[52:55], s15 offen sc0 sc1
    v_mfma_f32_32x32x16_bf16 v[32:47], v[104:107], v[68:71], v[32:47]
    ds_read_b128 v[64:67], v2 offset:22528
    s_add_u32 s15, s14, 25600
    buffer_load_dwordx4 v[92:95], v2, s[52:55], s15 offen sc0 sc1
    s_waitcnt lgkmcnt(3)
    v_mfma_f32_32x32x16_bf16 v[16:31], v[108:111], v[48:51], v[16:31]
    ds_read_b128 v[68:71], v2 offset:23552
    s_add_u32 s15, s14, 30720
    buffer_load_dwordx4 v[96:99], v2, s[52:55], s15 offen sc0 sc1
    v_mfma_f32_32x32x16_bf16 v[32:47], v[108:111], v[52:55], v[32:47]
    ds_read_b128 v[48:51], v2 offset:24576
    s_add_u32 s15, s14, 34816
    buffer_load_dwordx4 v[100:103], v2, s[52:55], s15 offen sc0 sc1
    s_waitcnt lgkmcnt(3)
    v_mfma_f32_32x32x16_bf16 v[16:31], v[112:115], v[56:59], v[16:31]
    ds_read_b128 v[52:55], v2 offset:25600
    s_add_u32 s15, s14, 8192
    buffer_load_dwordx4 v[104:107], v2, s[52:55], s15 offen sc0 sc1
    v_mfma_f32_32x32x16_bf16 v[32:47], v[112:115], v[60:63], v[32:47]
    ds_read_b128 v[56:59], v2 offset:26624
    s_add_u32 s15, s14, 17408
    buffer_load_dwordx4 v[108:111], v2, s[52:55], s15 offen sc0 sc1
    s_waitcnt lgkmcnt(3)
    v_mfma_f32_32x32x16_bf16 v[16:31], v[116:119], v[64:67], v[16:31]
    ds_read_b128 v[60:63], v2 offset:27648
    s_add_u32 s15, s14, 26624
    buffer_load_dwordx4 v[112:115], v2, s[52:55], s15 offen sc0 sc1
    v_mfma_f32_32x32x16_bf16 v[32:47], v[116:119], v[68:71], v[32:47]
    ds_read_b128 v[64:67], v2 offset:28672
    s_add_u32 s15, s14, 35840
    buffer_load_dwordx4 v[116:119], v2, s[52:55], s15 offen sc0 sc1
    s_waitcnt lgkmcnt(3)
    s_waitcnt vmcnt(22)
    v_mfma_f32_32x32x16_bf16 v[16:31], v[120:123], v[48:51], v[16:31]
    ds_read_b32 v14, v15 offset:40
    ds_read_b128 v[68:71], v2 offset:29696
    v_mfma_f32_32x32x16_bf16 v[32:47], v[120:123], v[52:55], v[32:47]
    ds_read_b128 v[48:51], v2 offset:30720
    s_waitcnt lgkmcnt(4)
    v_mfma_f32_32x32x16_bf16 v[16:31], v[124:127], v[56:59], v[16:31]
    ds_read_b128 v[52:55], v2 offset:31744
    v_mfma_f32_32x32x16_bf16 v[32:47], v[124:127], v[60:63], v[32:47]
    s_waitcnt lgkmcnt(3)
    v_cmp_ne_u32 vcc, 8, v14
    s_nop 4
    s_cbranch_vccz L_cok2
    s_mov_b32 s59, 0
WL17:
WI17:
    ds_read_b32 v14, v15 offset:40
    s_add_u32 s59, s59, 1
    s_waitcnt lgkmcnt(0)
    v_cmp_ne_u32 vcc, 8, v14
    s_cmp_ge_u32 s59, 524288
    s_cbranch_scc1 WX17
    s_nop 2
    s_cbranch_vccnz WL17
WX17:
L_cok2:
    ds_read_b128 v[56:59], v2 offset:32768
    s_waitcnt vmcnt(20)
    v_mfma_f32_32x32x16_bf16 v[16:31], v[128:131], v[64:67], v[16:31]
    ds_read_b128 v[60:63], v2 offset:33792
    s_waitcnt lgkmcnt(3)
    v_mfma_f32_32x32x16_bf16 v[32:47], v[128:131], v[68:71], v[32:47]
    ds_read_b128 v[64:67], v2 offset:34816
    v_mfma_f32_32x32x16_bf16 v[16:31], v[132:135], v[48:51], v[16:31]
    ds_read_b128 v[68:71], v2 offset:35840
    s_waitcnt lgkmcnt(3)
    v_mfma_f32_32x32x16_bf16 v[32:47], v[132:135], v[52:55], v[32:47]
    ds_read_b128 v[48:51], v2 offset:36864
    s_waitcnt vmcnt(18)
    v_mfma_f32_32x32x16_bf16 v[16:31], v[136:139], v[56:59], v[16:31]
    ds_read_b128 v[52:55], v2 offset:37888
    s_waitcnt lgkmcnt(3)
    v_mfma_f32_32x32x16_bf16 v[32:47], v[136:139], v[60:63], v[32:47]
    ds_read_b128 v[56:59], v2 offset:38912
    v_mfma_f32_32x32x16_bf16 v[16:31], v[140:143], v[64:67], v[16:31]
    ds_read_b128 v[60:63], v2 offset:39936
    s_waitcnt lgkmcnt(3)
    v_mfma_f32_32x32x16_bf16 v[32:47], v[140:143], v[68:71], v[32:47]
    ds_read_b128 v[64:67], v2 offset:40960
    s_waitcnt vmcnt(16)
    v_mfma_f32_32x32x16_bf16 v[16:31], v[144:147], v[48:51], v[16:31]
    ds_read_b128 v[68:71], v2 offset:41984
    s_waitcnt lgkmcnt(3)
    v_mfma_f32_32x32x16_bf16 v[32:47], v[144:147], v[52:55], v[32:47]
    ds_read_b128 v[48:51], v2 offset:43008
    v_mfma_f32_32x32x16_bf16 v[16:31], v[148:151], v[56:59], v[16:31]
    ds_read_b128 v[52:55], v2 offset:44032
    s_waitcnt lgkmcnt(3)
    v_mfma_f32_32x32x16_bf16 v[32:47], v[148:151], v[60:63], v[32:47]
    ds_read_b128 v[56:59], v2 offset:45056
    s_waitcnt vmcnt(14)
    v_mfma_f32_32x32x16_bf16 v[16:31], v[152:155], v[64:67], v[16:31]
    ds_read_b32 v14, v15 offset:44
    ds_read_b128 v[60:63], v2 offset:46080
    s_waitcnt lgkmcnt(4)
    v_mfma_f32_32x32x16_bf16 v[32:47], v[152:155], v[68:71], v[32:47]
    ds_read_b128 v[64:67], v2 offset:47104
    v_mfma_f32_32x32x16_bf16 v[16:31], v[156:159], v[48:51], v[16:31]
    ds_read_b128 v[68:71], v2 offset:48128
    s_waitcnt lgkmcnt(4)
    v_mfma_f32_32x32x16_bf16 v[32:47], v[156:159], v[52:55], v[32:47]
    s_waitcnt lgkmcnt(3)
    v_cmp_ne_u32 vcc, 8, v14
    s_nop 4
    s_cbranch_vccz L_cok3
    s_mov_b32 s59, 0
WL18:
WI18:
    ds_read_b32 v14, v15 offset:44
    s_add_u32 s59, s59, 1
    s_waitcnt lgkmcnt(0)
    v_cmp_ne_u32 vcc, 8, v14
    s_cmp_ge_u32 s59, 524288
    s_cbranch_scc1 WX18
    s_nop 2
    s_cbranch_vccnz WL18
WX18:
L_cok3:
    ds_read_b128 v[48:51], v2 offset:49152
    s_waitcnt vmcnt(12)
    v_mfma_f32_32x32x16_bf16 v[16:31], v[160:163], v[56:59], v[16:31]
    ds_read_b128 v[52:55], v2 offset:50176
    s_waitcnt lgkmcnt(3)
    v_mfma_f32_32x32x16_bf16 v[32:47], v[160:163], v[60:63], v[32:47]
    ds_read_b128 v[56:59], v2 offset:51200
    v_mfma_f32_32x32x16_bf16 v[16:31], v[164:167], v[64:67], v[16:31]
    ds_read_b128 v[60:63], v2 offset:52224
    s_waitcnt lgkmcnt(3)
    v_mfma_f32_32x32x16_bf16 v[32:47], v[164:167], v[68:71], v[32:47]
    ds_read_b128 v[64:67], v2 offset:53248
    s_waitcnt vmcnt(10)
    v_mfma_f32_32x32x16_bf16 v[16:31], v[72:75], v[48:51], v[16:31]
    ds_read_b128 v[68:71], v2 offset:54272
    s_waitcnt lgkmcnt(3)
    v_mfma_f32_32x32x16_bf16 v[32:47], v[72:75], v[52:55], v[32:47]
    ds_read_b128 v[48:51], v2 offset:55296
    v_mfma_f32_32x32x16_bf16 v[16:31], v[76:79], v[56:59], v[16:31]
    ds_read_b128 v[52:55], v2 offset:56320
    s_waitcnt lgkmcnt(3)
    v_mfma_f32_32x32x16_bf16 v[32:47], v[76:79], v[60:63], v[32:47]
    ds_read_b128 v[56:59], v2 offset:57344
    s_waitcnt vmcnt(8)
    v_mfma_f32_32x32x16_bf16 v[16:31], v[80:83], v[64:67], v[16:31]
    ds_read_b128 v[60:63], v2 offset:58368
    s_waitcnt lgkmcnt(3)
    v_mfma_f32_32x32x16_bf16 v[32:47], v[80:83], v[68:71], v[32:47]
    ds_read_b128 v[64:67], v2 offset:59392
    v_mfma_f32_32x32x16_bf16 v[16:31], v[84:87], v[48:51], v[16:31]
    ds_read_b128 v[68:71], v2 offset:60416
    s_waitcnt lgkmcnt(3)
    v_mfma_f32_32x32x16_bf16 v[32:47], v[84:87], v[52:55], v[32:47]
    ds_read_b128 v[48:51], v2 offset:61440
    s_waitcnt vmcnt(6)
    v_mfma_f32_32x32x16_bf16 v[16:31], v[88:91], v[56:59], v[16:31]
    ds_read_b128 v[52:55], v2 offset:62464
    s_waitcnt lgkmcnt(3)
    v_mfma_f32_32x32x16_bf16 v[32:47], v[88:91], v[60:63], v[32:47]
    ds_read_b128 v[56:59], v2 offset:63488
    v_mfma_f32_32x32x16_bf16 v[16:31], v[92:95], v[64:67], v[16:31]
    ds_read_b128 v[60:63], v2 offset:64512
    s_waitcnt lgkmcnt(3)
    v_mfma_f32_32x32x16_bf16 v[32:47], v[92:95], v[68:71], v[32:47]
    ds_read_b128 v[64:67], v9 offset:0
    s_waitcnt vmcnt(4)
    v_mfma_f32_32x32x16_bf16 v[16:31], v[96:99], v[48:51], v[16:31]
    ds_read_b128 v[68:71], v9 offset:1024
    s_waitcnt lgkmcnt(3)
    v_mfma_f32_32x32x16_bf16 v[32:47], v[96:99], v[52:55], v[32:47]
    ds_read_b128 v[48:51], v9 offset:2048
    v_mfma_f32_32x32x16_bf16 v[16:31], v[100:103], v[56:59], v[16:31]
    ds_read_b128 v[52:55], v9 offset:3072
    s_waitcnt lgkmcnt(3)
    v_mfma_f32_32x32x16_bf16 v[32:47], v[100:103], v[60:63], v[32:47]
    ds_read_b128 v[56:59], v9 offset:4096
    s_waitcnt vmcnt(2)
    v_mfma_f32_32x32x16_bf16 v[16:31], v[104:107], v[64:67], v[16:31]
    ds_read_b128 v[60:63], v9 offset:5120
    s_waitcnt lgkmcnt(3)
    v_mfma_f32_32x32x16_bf16 v[32:47], v[104:107], v[68:71], v[32:47]
    ds_read_b128 v[64:67], v9 offset:6144
    v_mfma_f32_32x32x16_bf16 v[16:31], v[108:111], v[48:51], v[16:31]
    ds_read_b128 v[68:71], v9 offset:7168
    s_waitcnt lgkmcnt(3)
    v_mfma_f32_32x32x16_bf16 v[32:47], v[108:111], v[52:55], v[32:47]
    s_waitcnt vmcnt(0)
    v_mfma_f32_32x32x16_bf16 v[16:31], v[112:115], v[56:59], v[16:31]
    s_waitcnt lgkmcnt(2)
    v_mfma_f32_32x32x16_bf16 v[32:47], v[112:115], v[60:63], v[32:47]
    s_waitcnt lgkmcnt(1)
    v_mfma_f32_32x32x16_bf16 v[16:31], v[116:119], v[64:67], v[16:31]
    s_waitcnt lgkmcnt(0)
    v_mfma_f32_32x32x16_bf16 v[32:47], v[116:119], v[68:71], v[32:47]
    s_nop 9
    v_cvt_pk_bf16_f32 v48, v16, v17
    v_cvt_pk_bf16_f32 v49, v18, v19
    v_cvt_pk_bf16_f32 v50, v20, v21
    v_cvt_pk_bf16_f32 v51, v22, v23
    v_cvt_pk_bf16_f32 v52, v24, v25
    v_cvt_pk_bf16_f32 v53, v26, v27
    v_cvt_pk_bf16_f32 v54, v28, v29
    v_cvt_pk_bf16_f32 v55, v30, v31
    ds_write_b128 v12, v[48:51] offset:0
    ds_write_b128 v12, v[52:55] offset:16
    v_cvt_pk_bf16_f32 v56, v32, v33
    v_cvt_pk_bf16_f32 v57, v34, v35
    v_cvt_pk_bf16_f32 v58, v36, v37
    v_cvt_pk_bf16_f32 v59, v38, v39
    v_cvt_pk_bf16_f32 v60, v40, v41
    v_cvt_pk_bf16_f32 v61, v42, v43
    v_cvt_pk_bf16_f32 v62, v44, v45
    v_cvt_pk_bf16_f32 v63, v46, v47
    ds_write_b128 v12, v[56:59] offset:2560
    ds_write_b128 v12, v[60:63] offset:2576
    ds_read_b128 v[80:83], v13 offset:0
    ds_read_b128 v[84:87], v13 offset:1280
    ds_read_b128 v[88:91], v13 offset:2560
    ds_read_b128 v[92:95], v13 offset:3840
    s_waitcnt lgkmcnt(3)
    buffer_store_dwordx4 v[80:83], v10, s[44:47], s12 offen nt
    s_add_u32 s12, s12, 36864
    s_waitcnt lgkmcnt(2)
    buffer_store_dwordx4 v[84:87], v10, s[44:47], s12 offen nt
    s_add_u32 s12, s12, 36864
    s_waitcnt lgkmcnt(1)
    buffer_store_dwordx4 v[88:91], v10, s[44:47], s12 offen nt
    s_add_u32 s12, s12, 36864
    s_waitcnt lgkmcnt(0)
    buffer_store_dwordx4 v[92:95], v10, s[44:47], s12 offen nt
    s_endpgm
L_q:
    s_and_b32 s8, s3, 1
    s_lshr_b32 s9, s3, 1
    v_lshrrev_b32 v7, 2, v6
    v_lshrrev_b32 v8, 5, v0
    v_lshl_add_u32 v9, v8, 3, v7
    v_mul_u32_u24 v9, 384, v9
    v_and_b32 v10, 1, v5
    v_lshl_add_u32 v9, v10, 5, v9
    v_and_b32 v10, 1, v0
    v_lshl_add_u32 v9, v10, 4, v9
    v_bfe_u32 v10, v0, 1, 1
    v_lshl_add_u32 v9, v10, 3, v9
    v_lshrrev_b32 v7, 1, v7
    s_mul_i32 s14, s9, 3
    v_xor_b32 v10, s14, v7
    v_lshl_add_u32 v2, v10, 6, v9
    s_add_u32 s14, s14, 1
    v_xor_b32 v10, s14, v7
    v_lshl_add_u32 v3, v10, 6, v9
    v_and_b32 v10, 31, v0
    v_bfe_u32 v11, v0, 1, 3
    v_xor_b32 v11, v11, v8
    v_lshlrev_b32 v4, 7, v10
    v_lshl_add_u32 v4, v11, 4, v4
    s_lshl_b32 s14, s8, 13
    s_add_u32 s14, s14, 24576
    v_add_u32 v4, s14, v4
    v_mov_b64 v[16:17], 0
    v_mov_b64 v[18:19], 0
    v_mov_b64 v[20:21], 0
    v_mov_b64 v[22:23], 0
    v_mov_b64 v[24:25], 0
    v_mov_b64 v[26:27], 0
    v_mov_b64 v[28:29], 0
    v_mov_b64 v[30:31], 0
    v_mov_b64 v[32:33], 0
    v_mov_b64 v[34:35], 0
    v_mov_b64 v[36:37], 0
    v_mov_b64 v[38:39], 0
    v_mov_b64 v[40:41], 0
    v_mov_b64 v[42:43], 0
    v_mov_b64 v[44:45], 0
    v_mov_b64 v[46:47], 0
    v_mov_b64 v[48:49], 0
    v_mov_b64 v[50:51], 0
    v_mov_b64 v[52:53], 0
    v_mov_b64 v[54:55], 0
    v_mov_b64 v[56:57], 0
    v_mov_b64 v[58:59], 0
    v_mov_b64 v[60:61], 0
    v_mov_b64 v[62:63], 0
    v_mov_b64 v[64:65], 0
    v_mov_b64 v[66:67], 0
    v_mov_b64 v[68:69], 0
    v_mov_b64 v[70:71], 0
    v_mov_b64 v[72:73], 0
    v_mov_b64 v[74:75], 0
    v_mov_b64 v[76:77], 0
    v_mov_b64 v[78:79], 0
    v_mov_b64 v[80:81], 0
    v_mov_b64 v[82:83], 0
    v_mov_b64 v[84:85], 0
    v_mov_b64 v[86:87], 0
    v_mov_b64 v[88:89], 0
    v_mov_b64 v[90:91], 0
    v_mov_b64 v[92:93], 0
    v_mov_b64 v[94:95], 0
    v_mov_b64 v[96:97], 0
    v_mov_b64 v[98:99], 0
    v_mov_b64 v[100:101], 0
    v_mov_b64 v[102:103], 0
    v_mov_b64 v[104:105], 0
    v_mov_b64 v[106:107], 0
    v_mov_b64 v[108:109], 0
    v_mov_b64 v[110:111], 0
    s_mov_b32 s65, 0
    s_mov_b32 s67, 40960
    s_waitcnt lgkmcnt(0)
    s_mov_b32 s52, s40
    s_mov_b32 s53, s41
    s_mov_b32 s54, 268435456
    s_mov_b32 s55, 0x20000
    s_lshl_b32 s14, s6, 1
    s_add_u32 s14, s14, s8
    s_mul_i32 s14, s14, 72
    s_mul_i32 s15, s10, 12
    s_add_u32 s14, s14, s15
    s_mul_i32 s15, s9, 6
    s_add_u32 s14, s14, s15
    s_lshl_b32 s14, s14, 10
    s_add_u32 s15, s14, 36864
    v_lshlrev_b32 v12, 4, v0
    v_mov_b32 v11, 1
    v_mov_b32 v15, 77312
    s_barrier
    ds_read_b128 v[136:139], v4 offset:0
    ds_read_b64_tr_b16 v[112:113], v2 offset:0
    ds_read_b64_tr_b16 v[114:115], v2 offset:1536
    ds_read_b128 v[140:143], v4 offset:4096
    ds_read_b64_tr_b16 v[116:117], v3 offset:0
    ds_read_b64_tr_b16 v[118:119], v3 offset:1536
    ds_read_b64_tr_b16 v[120:121], v2 offset:128
    ds_read_b64_tr_b16 v[122:123], v2 offset:1664
    v_xor_b32 v7, 32, v4
L_qloop:
    s_waitcnt lgkmcnt(4)
    v_mfma_f32_32x32x16_bf16 v[16:31], v[112:115], v[136:139], v[16:31]
    ds_read_b128 v[144:147], v7 offset:0
    ds_read_b64_tr_b16 v[124:125], v2 offset:6144
    v_mfma_f32_32x32x16_bf16 v[32:47], v[112:115], v[140:143], v[32:47]
    ds_read_b64_tr_b16 v[126:127], v2 offset:7680
    s_waitcnt lgkmcnt(5)
    v_mfma_f32_32x32x16_bf16 v[48:63], v[116:119], v[136:139], v[48:63]
    ds_read_b128 v[148:151], v7 offset:4096
    ds_read_b64_tr_b16 v[128:129], v3 offset:6144
    v_mfma_f32_32x32x16_bf16 v[64:79], v[116:119], v[140:143], v[64:79]
    ds_read_b64_tr_b16 v[130:131], v3 offset:7680
    v_xor_b32 v7, 64, v4
    s_waitcnt lgkmcnt(6)
    v_mfma_f32_32x32x16_bf16 v[80:95], v[120:123], v[136:139], v[80:95]
    ds_read_b64_tr_b16 v[132:133], v2 offset:6272
    s_add_u32 s65, s65, 1
    s_and_b32 s66, s65, 3
    s_cselect_b32 s66, s67, 4294844416
    v_mfma_f32_32x32x16_bf16 v[96:111], v[120:123], v[140:143], v[96:111]
    ds_read_b64_tr_b16 v[134:135], v2 offset:7808
    s_waitcnt lgkmcnt(4)
    v_mfma_f32_32x32x16_bf16 v[16:31], v[124:127], v[144:147], v[16:31]
    ds_read_b128 v[136:139], v7 offset:0
    ds_read_b64_tr_b16 v[112:113], v2 offset:12288
    v_mfma_f32_32x32x16_bf16 v[32:47], v[124:127], v[148:151], v[32:47]
    ds_read_b64_tr_b16 v[114:115], v2 offset:13824
    s_waitcnt lgkmcnt(5)
    v_mfma_f32_32x32x16_bf16 v[48:63], v[128:131], v[144:147], v[48:63]
    ds_read_b128 v[140:143], v7 offset:4096
    ds_read_b64_tr_b16 v[116:117], v3 offset:12288
    v_mfma_f32_32x32x16_bf16 v[64:79], v[128:131], v[148:151], v[64:79]
    ds_read_b64_tr_b16 v[118:119], v3 offset:13824
    v_xor_b32 v7, 96, v4
    s_waitcnt lgkmcnt(6)
    v_mfma_f32_32x32x16_bf16 v[80:95], v[132:135], v[144:147], v[80:95]
    ds_read_b64_tr_b16 v[120:121], v2 offset:12416
    v_mfma_f32_32x32x16_bf16 v[96:111], v[132:135], v[148:151], v[96:111]
    ds_read_b64_tr_b16 v[122:123], v2 offset:13952
    s_waitcnt lgkmcnt(4)
    v_mfma_f32_32x32x16_bf16 v[16:31], v[112:115], v[136:139], v[16:31]
    ds_read_b128 v[144:147], v7 offset:0
    ds_read_b64_tr_b16 v[124:125], v2 offset:18432
    v_mfma_f32_32x32x16_bf16 v[32:47], v[112:115], v[140:143], v[32:47]
    ds_read_b64_tr_b16 v[126:127], v2 offset:19968
    s_waitcnt lgkmcnt(5)
    v_mfma_f32_32x32x16_bf16 v[48:63], v[116:119], v[136:139], v[48:63]
    ds_read_b128 v[148:151], v7 offset:4096
    ds_read_b64_tr_b16 v[128:129], v3 offset:18432
    v_mfma_f32_32x32x16_bf16 v[64:79], v[116:119], v[140:143], v[64:79]
    ds_read_b64_tr_b16 v[130:131], v3 offset:19968
    v_add_u32 v4, s66, v4
    s_waitcnt lgkmcnt(6)
    v_mfma_f32_32x32x16_bf16 v[80:95], v[120:123], v[136:139], v[80:95]
    ds_read_b64_tr_b16 v[132:133], v2 offset:18560
    v_mfma_f32_32x32x16_bf16 v[96:111], v[120:123], v[140:143], v[96:111]
    ds_read_b64_tr_b16 v[134:135], v2 offset:20096
    s_waitcnt lgkmcnt(4)
    v_mfma_f32_32x32x16_bf16 v[16:31], v[124:127], v[144:147], v[16:31]
    v_add_u32 v2, s66, v2
    v_add_u32 v3, s66, v3
    s_barrier
    ds_read_b128 v[136:139], v4 offset:0
    ds_read_b64_tr_b16 v[112:113], v2 offset:0
    v_mfma_f32_32x32x16_bf16 v[32:47], v[124:127], v[148:151], v[32:47]
    ds_read_b64_tr_b16 v[114:115], v2 offset:1536
    s_waitcnt lgkmcnt(5)
    v_mfma_f32_32x32x16_bf16 v[48:63], v[128:131], v[144:147], v[48:63]
    ds_read_b128 v[140:143], v4 offset:4096
    ds_read_b64_tr_b16 v[116:117], v3 offset:0
    v_mfma_f32_32x32x16_bf16 v[64:79], v[128:131], v[148:151], v[64:79]
    ds_read_b64_tr_b16 v[118:119], v3 offset:1536
    v_xor_b32 v7, 32, v4
    s_waitcnt lgkmcnt(6)
    v_mfma_f32_32x32x16_bf16 v[80:95], v[132:135], v[144:147], v[80:95]
    ds_read_b64_tr_b16 v[120:121], v2 offset:128
    s_cmp_lt_u32 s65, 9
    v_mfma_f32_32x32x16_bf16 v[96:111], v[132:135], v[148:151], v[96:111]
    ds_read_b64_tr_b16 v[122:123], v2 offset:1664
    s_cbranch_scc1 L_qloop
    s_mov_b32 s68, 0x3fb8aa3b
    s_mov_b32 s69, 0x3fb8aa3b
    s_mov_b32 s70, 0x358637bd
    s_setprio 3
    s_waitcnt lgkmcnt(0)
    v_pk_mul_f32 v[152:153], v[16:17], s[68:69]
    v_pk_mul_f32 v[154:155], v[18:19], s[68:69]
    v_pk_mul_f32 v[156:157], v[20:21], s[68:69]
    v_pk_mul_f32 v[158:159], v[22:23], s[68:69]
    v_exp_f32 v152, v152 clamp
    v_exp_f32 v153, v153 clamp
    v_exp_f32 v154, v154 clamp
    v_exp_f32 v155, v155 clamp
    v_exp_f32 v156, v156 clamp
    v_exp_f32 v157, v157 clamp
    v_exp_f32 v158, v158 clamp
    v_exp_f32 v159, v159 clamp
    v_max_f32 v16, s70, v16
    v_max_f32 v17, s70, v17
    v_max_f32 v18, s70, v18
    v_max_f32 v19, s70, v19
    v_max_f32 v20, s70, v20
    v_max_f32 v21, s70, v21
    v_max_f32 v22, s70, v22
    v_max_f32 v23, s70, v23
    v_pk_add_f32 v[16:17], v[16:17], v[152:153]
    v_pk_add_f32 v[18:19], v[18:19], v[154:155]
    v_pk_add_f32 v[20:21], v[20:21], v[156:157]
    v_pk_add_f32 v[22:23], v[22:23], v[158:159]
    v_cvt_pk_bf16_f32 v112, v16, v17
    v_cvt_pk_bf16_f32 v113, v18, v19
    v_cvt_pk_bf16_f32 v114, v20, v21
    v_cvt_pk_bf16_f32 v115, v22, v23
    buffer_store_dwordx4 v[112:115], v12, s[52:55], s14 offen offset:0 sc0 sc1
    v_pk_mul_f32 v[152:153], v[24:25], s[68:69]
    v_pk_mul_f32 v[154:155], v[26:27], s[68:69]
    v_pk_mul_f32 v[156:157], v[28:29], s[68:69]
    v_pk_mul_f32 v[158:159], v[30:31], s[68:69]
    v_exp_f32 v152, v152 clamp
    v_exp_f32 v153, v153 clamp
    v_exp_f32 v154, v154 clamp
    v_exp_f32 v155, v155 clamp
    v_exp_f32 v156, v156 clamp
    v_exp_f32 v157, v157 clamp
    v_exp_f32 v158, v158 clamp
    v_exp_f32 v159, v159 clamp
    v_max_f32 v24, s70, v24
    v_max_f32 v25, s70, v25
    v_max_f32 v26, s70, v26
    v_max_f32 v27, s70, v27
    v_max_f32 v28, s70, v28
    v_max_f32 v29, s70, v29
    v_max_f32 v30, s70, v30
    v_max_f32 v31, s70, v31
    v_pk_add_f32 v[24:25], v[24:25], v[152:153]
    v_pk_add_f32 v[26:27], v[26:27], v[154:155]
    v_pk_add_f32 v[28:29], v[28:29], v[156:157]
    v_pk_add_f32 v[30:31], v[30:31], v[158:159]
    v_cvt_pk_bf16_f32 v116, v24, v25
    v_cvt_pk_bf16_f32 v117, v26, v27
    v_cvt_pk_bf16_f32 v118, v28, v29
    v_cvt_pk_bf16_f32 v119, v30, v31
    buffer_store_dwordx4 v[116:119], v12, s[52:55], s14 offen offset:1024 sc0 sc1
    s_add_u32 s14, s14, 2048
    v_pk_mul_f32 v[152:153], v[32:33], s[68:69]
    v_pk_mul_f32 v[154:155], v[34:35], s[68:69]
    v_pk_mul_f32 v[156:157], v[36:37], s[68:69]
    v_pk_mul_f32 v[158:159], v[38:39], s[68:69]
    v_exp_f32 v152, v152 clamp
    v_exp_f32 v153, v153 clamp
    v_exp_f32 v154, v154 clamp
    v_exp_f32 v155, v155 clamp
    v_exp_f32 v156, v156 clamp
    v_exp_f32 v157, v157 clamp
    v_exp_f32 v158, v158 clamp
    v_exp_f32 v159, v159 clamp
    v_max_f32 v32, s70, v32
    v_max_f32 v33, s70, v33
    v_max_f32 v34, s70, v34
    v_max_f32 v35, s70, v35
    v_max_f32 v36, s70, v36
    v_max_f32 v37, s70, v37
    v_max_f32 v38, s70, v38
    v_max_f32 v39, s70, v39
    v_pk_add_f32 v[32:33], v[32:33], v[152:153]
    v_pk_add_f32 v[34:35], v[34:35], v[154:155]
    v_pk_add_f32 v[36:37], v[36:37], v[156:157]
    v_pk_add_f32 v[38:39], v[38:39], v[158:159]
    v_cvt_pk_bf16_f32 v120, v32, v33
    v_cvt_pk_bf16_f32 v121, v34, v35
    v_cvt_pk_bf16_f32 v122, v36, v37
    v_cvt_pk_bf16_f32 v123, v38, v39
    buffer_store_dwordx4 v[120:123], v12, s[52:55], s15 offen offset:0 sc0 sc1
    v_pk_mul_f32 v[152:153], v[40:41], s[68:69]
    v_pk_mul_f32 v[154:155], v[42:43], s[68:69]
    v_pk_mul_f32 v[156:157], v[44:45], s[68:69]
    v_pk_mul_f32 v[158:159], v[46:47], s[68:69]
    v_exp_f32 v152, v152 clamp
    v_exp_f32 v153, v153 clamp
    v_exp_f32 v154, v154 clamp
    v_exp_f32 v155, v155 clamp
    v_exp_f32 v156, v156 clamp
    v_exp_f32 v157, v157 clamp
    v_exp_f32 v158, v158 clamp
    v_exp_f32 v159, v159 clamp
    v_max_f32 v40, s70, v40
    v_max_f32 v41, s70, v41
    v_max_f32 v42, s70, v42
    v_max_f32 v43, s70, v43
    v_max_f32 v44, s70, v44
    v_max_f32 v45, s70, v45
    v_max_f32 v46, s70, v46
    v_max_f32 v47, s70, v47
    v_pk_add_f32 v[40:41], v[40:41], v[152:153]
    v_pk_add_f32 v[42:43], v[42:43], v[154:155]
    v_pk_add_f32 v[44:45], v[44:45], v[156:157]
    v_pk_add_f32 v[46:47], v[46:47], v[158:159]
    v_cvt_pk_bf16_f32 v124, v40, v41
    v_cvt_pk_bf16_f32 v125, v42, v43
    v_cvt_pk_bf16_f32 v126, v44, v45
    v_cvt_pk_bf16_f32 v127, v46, v47
    buffer_store_dwordx4 v[124:127], v12, s[52:55], s15 offen offset:1024 sc0 sc1
    s_add_u32 s15, s15, 2048
    v_pk_mul_f32 v[152:153], v[48:49], s[68:69]
    v_pk_mul_f32 v[154:155], v[50:51], s[68:69]
    v_pk_mul_f32 v[156:157], v[52:53], s[68:69]
    v_pk_mul_f32 v[158:159], v[54:55], s[68:69]
    v_exp_f32 v152, v152 clamp
    v_exp_f32 v153, v153 clamp
    v_exp_f32 v154, v154 clamp
    v_exp_f32 v155, v155 clamp
    v_exp_f32 v156, v156 clamp
    v_exp_f32 v157, v157 clamp
    v_exp_f32 v158, v158 clamp
    v_exp_f32 v159, v159 clamp
    v_max_f32 v48, s70, v48
    v_max_f32 v49, s70, v49
    v_max_f32 v50, s70, v50
    v_max_f32 v51, s70, v51
    v_max_f32 v52, s70, v52
    v_max_f32 v53, s70, v53
    v_max_f32 v54, s70, v54
    v_max_f32 v55, s70, v55
    v_pk_add_f32 v[48:49], v[48:49], v[152:153]
    v_pk_add_f32 v[50:51], v[50:51], v[154:155]
    v_pk_add_f32 v[52:53], v[52:53], v[156:157]
    v_pk_add_f32 v[54:55], v[54:55], v[158:159]
    v_cvt_pk_bf16_f32 v128, v48, v49
    v_cvt_pk_bf16_f32 v129, v50, v51
    v_cvt_pk_bf16_f32 v130, v52, v53
    v_cvt_pk_bf16_f32 v131, v54, v55
    buffer_store_dwordx4 v[128:131], v12, s[52:55], s14 offen offset:0 sc0 sc1
    v_pk_mul_f32 v[152:153], v[56:57], s[68:69]
    v_pk_mul_f32 v[154:155], v[58:59], s[68:69]
    v_pk_mul_f32 v[156:157], v[60:61], s[68:69]
    v_pk_mul_f32 v[158:159], v[62:63], s[68:69]
    v_exp_f32 v152, v152 clamp
    v_exp_f32 v153, v153 clamp
    v_exp_f32 v154, v154 clamp
    v_exp_f32 v155, v155 clamp
    v_exp_f32 v156, v156 clamp
    v_exp_f32 v157, v157 clamp
    v_exp_f32 v158, v158 clamp
    v_exp_f32 v159, v159 clamp
    v_max_f32 v56, s70, v56
    v_max_f32 v57, s70, v57
    v_max_f32 v58, s70, v58
    v_max_f32 v59, s70, v59
    v_max_f32 v60, s70, v60
    v_max_f32 v61, s70, v61
    v_max_f32 v62, s70, v62
    v_max_f32 v63, s70, v63
    v_pk_add_f32 v[56:57], v[56:57], v[152:153]
    v_pk_add_f32 v[58:59], v[58:59], v[154:155]
    v_pk_add_f32 v[60:61], v[60:61], v[156:157]
    v_pk_add_f32 v[62:63], v[62:63], v[158:159]
    v_cvt_pk_bf16_f32 v132, v56, v57
    v_cvt_pk_bf16_f32 v133, v58, v59
    v_cvt_pk_bf16_f32 v134, v60, v61
    v_cvt_pk_bf16_f32 v135, v62, v63
    buffer_store_dwordx4 v[132:135], v12, s[52:55], s14 offen offset:1024 sc0 sc1
    s_add_u32 s14, s14, 2048
    v_pk_mul_f32 v[152:153], v[64:65], s[68:69]
    v_pk_mul_f32 v[154:155], v[66:67], s[68:69]
    v_pk_mul_f32 v[156:157], v[68:69], s[68:69]
    v_pk_mul_f32 v[158:159], v[70:71], s[68:69]
    v_exp_f32 v152, v152 clamp
    v_exp_f32 v153, v153 clamp
    v_exp_f32 v154, v154 clamp
    v_exp_f32 v155, v155 clamp
    v_exp_f32 v156, v156 clamp
    v_exp_f32 v157, v157 clamp
    v_exp_f32 v158, v158 clamp
    v_exp_f32 v159, v159 clamp
    v_max_f32 v64, s70, v64
    v_max_f32 v65, s70, v65
    v_max_f32 v66, s70, v66
    v_max_f32 v67, s70, v67
    v_max_f32 v68, s70, v68
    v_max_f32 v69, s70, v69
    v_max_f32 v70, s70, v70
    v_max_f32 v71, s70, v71
    v_pk_add_f32 v[64:65], v[64:65], v[152:153]
    v_pk_add_f32 v[66:67], v[66:67], v[154:155]
    v_pk_add_f32 v[68:69], v[68:69], v[156:157]
    v_pk_add_f32 v[70:71], v[70:71], v[158:159]
    v_cvt_pk_bf16_f32 v136, v64, v65
    v_cvt_pk_bf16_f32 v137, v66, v67
    v_cvt_pk_bf16_f32 v138, v68, v69
    v_cvt_pk_bf16_f32 v139, v70, v71
    buffer_store_dwordx4 v[136:139], v12, s[52:55], s15 offen offset:0 sc0 sc1
    v_pk_mul_f32 v[152:153], v[72:73], s[68:69]
    v_pk_mul_f32 v[154:155], v[74:75], s[68:69]
    v_pk_mul_f32 v[156:157], v[76:77], s[68:69]
    v_pk_mul_f32 v[158:159], v[78:79], s[68:69]
    v_exp_f32 v152, v152 clamp
    v_exp_f32 v153, v153 clamp
    v_exp_f32 v154, v154 clamp
    v_exp_f32 v155, v155 clamp
    v_exp_f32 v156, v156 clamp
    v_exp_f32 v157, v157 clamp
    v_exp_f32 v158, v158 clamp
    v_exp_f32 v159, v159 clamp
    v_max_f32 v72, s70, v72
    v_max_f32 v73, s70, v73
    v_max_f32 v74, s70, v74
    v_max_f32 v75, s70, v75
    v_max_f32 v76, s70, v76
    v_max_f32 v77, s70, v77
    v_max_f32 v78, s70, v78
    v_max_f32 v79, s70, v79
    v_pk_add_f32 v[72:73], v[72:73], v[152:153]
    v_pk_add_f32 v[74:75], v[74:75], v[154:155]
    v_pk_add_f32 v[76:77], v[76:77], v[156:157]
    v_pk_add_f32 v[78:79], v[78:79], v[158:159]
    v_cvt_pk_bf16_f32 v140, v72, v73
    v_cvt_pk_bf16_f32 v141, v74, v75
    v_cvt_pk_bf16_f32 v142, v76, v77
    v_cvt_pk_bf16_f32 v143, v78, v79
    buffer_store_dwordx4 v[140:143], v12, s[52:55], s15 offen offset:1024 sc0 sc1
    s_add_u32 s15, s15, 2048
    s_mov_b64 exec, 1
    ds_add_u32 v15, v11 offset:0
    s_mov_b64 exec, -1
    v_pk_mul_f32 v[152:153], v[80:81], s[68:69]
    v_pk_mul_f32 v[154:155], v[82:83], s[68:69]
    v_pk_mul_f32 v[156:157], v[84:85], s[68:69]
    v_pk_mul_f32 v[158:159], v[86:87], s[68:69]
    v_exp_f32 v152, v152 clamp
    v_exp_f32 v153, v153 clamp
    v_exp_f32 v154, v154 clamp
    v_exp_f32 v155, v155 clamp
    v_exp_f32 v156, v156 clamp
    v_exp_f32 v157, v157 clamp
    v_exp_f32 v158, v158 clamp
    v_exp_f32 v159, v159 clamp
    v_max_f32 v80, s70, v80
    v_max_f32 v81, s70, v81
    v_max_f32 v82, s70, v82
    v_max_f32 v83, s70, v83
    v_max_f32 v84, s70, v84
    v_max_f32 v85, s70, v85
    v_max_f32 v86, s70, v86
    v_max_f32 v87, s70, v87
    v_pk_add_f32 v[80:81], v[80:81], v[152:153]
    v_pk_add_f32 v[82:83], v[82:83], v[154:155]
    v_pk_add_f32 v[84:85], v[84:85], v[156:157]
    v_pk_add_f32 v[86:87], v[86:87], v[158:159]
    v_cvt_pk_bf16_f32 v112, v80, v81
    v_cvt_pk_bf16_f32 v113, v82, v83
    v_cvt_pk_bf16_f32 v114, v84, v85
    v_cvt_pk_bf16_f32 v115, v86, v87
    buffer_store_dwordx4 v[112:115], v12, s[52:55], s14 offen offset:0 sc0 sc1
    v_pk_mul_f32 v[152:153], v[88:89], s[68:69]
    v_pk_mul_f32 v[154:155], v[90:91], s[68:69]
    v_pk_mul_f32 v[156:157], v[92:93], s[68:69]
    v_pk_mul_f32 v[158:159], v[94:95], s[68:69]
    v_exp_f32 v152, v152 clamp
    v_exp_f32 v153, v153 clamp
    v_exp_f32 v154, v154 clamp
    v_exp_f32 v155, v155 clamp
    v_exp_f32 v156, v156 clamp
    v_exp_f32 v157, v157 clamp
    v_exp_f32 v158, v158 clamp
    v_exp_f32 v159, v159 clamp
    v_max_f32 v88, s70, v88
    v_max_f32 v89, s70, v89
    v_max_f32 v90, s70, v90
    v_max_f32 v91, s70, v91
    v_max_f32 v92, s70, v92
    v_max_f32 v93, s70, v93
    v_max_f32 v94, s70, v94
    v_max_f32 v95, s70, v95
    v_pk_add_f32 v[88:89], v[88:89], v[152:153]
    v_pk_add_f32 v[90:91], v[90:91], v[154:155]
    v_pk_add_f32 v[92:93], v[92:93], v[156:157]
    v_pk_add_f32 v[94:95], v[94:95], v[158:159]
    v_cvt_pk_bf16_f32 v116, v88, v89
    v_cvt_pk_bf16_f32 v117, v90, v91
    v_cvt_pk_bf16_f32 v118, v92, v93
    v_cvt_pk_bf16_f32 v119, v94, v95
    buffer_store_dwordx4 v[116:119], v12, s[52:55], s14 offen offset:1024 sc0 sc1
    s_add_u32 s14, s14, 2048
    v_pk_mul_f32 v[152:153], v[96:97], s[68:69]
    v_pk_mul_f32 v[154:155], v[98:99], s[68:69]
    v_pk_mul_f32 v[156:157], v[100:101], s[68:69]
    v_pk_mul_f32 v[158:159], v[102:103], s[68:69]
    v_exp_f32 v152, v152 clamp
    v_exp_f32 v153, v153 clamp
    v_exp_f32 v154, v154 clamp
    v_exp_f32 v155, v155 clamp
    v_exp_f32 v156, v156 clamp
    v_exp_f32 v157, v157 clamp
    v_exp_f32 v158, v158 clamp
    v_exp_f32 v159, v159 clamp
    v_max_f32 v96, s70, v96
    v_max_f32 v97, s70, v97
    v_max_f32 v98, s70, v98
    v_max_f32 v99, s70, v99
    v_max_f32 v100, s70, v100
    v_max_f32 v101, s70, v101
    v_max_f32 v102, s70, v102
    v_max_f32 v103, s70, v103
    v_pk_add_f32 v[96:97], v[96:97], v[152:153]
    v_pk_add_f32 v[98:99], v[98:99], v[154:155]
    v_pk_add_f32 v[100:101], v[100:101], v[156:157]
    v_pk_add_f32 v[102:103], v[102:103], v[158:159]
    v_cvt_pk_bf16_f32 v120, v96, v97
    v_cvt_pk_bf16_f32 v121, v98, v99
    v_cvt_pk_bf16_f32 v122, v100, v101
    v_cvt_pk_bf16_f32 v123, v102, v103
    buffer_store_dwordx4 v[120:123], v12, s[52:55], s15 offen offset:0 sc0 sc1
    v_pk_mul_f32 v[152:153], v[104:105], s[68:69]
    v_pk_mul_f32 v[154:155], v[106:107], s[68:69]
    v_pk_mul_f32 v[156:157], v[108:109], s[68:69]
    v_pk_mul_f32 v[158:159], v[110:111], s[68:69]
    v_exp_f32 v152, v152 clamp
    v_exp_f32 v153, v153 clamp
    v_exp_f32 v154, v154 clamp
    v_exp_f32 v155, v155 clamp
    v_exp_f32 v156, v156 clamp
    v_exp_f32 v157, v157 clamp
    v_exp_f32 v158, v158 clamp
    v_exp_f32 v159, v159 clamp
    v_max_f32 v104, s70, v104
    v_max_f32 v105, s70, v105
    v_max_f32 v106, s70, v106
    v_max_f32 v107, s70, v107
    v_max_f32 v108, s70, v108
    v_max_f32 v109, s70, v109
    v_max_f32 v110, s70, v110
    v_max_f32 v111, s70, v111
    v_pk_add_f32 v[104:105], v[104:105], v[152:153]
    v_pk_add_f32 v[106:107], v[106:107], v[154:155]
    v_pk_add_f32 v[108:109], v[108:109], v[156:157]
    v_pk_add_f32 v[110:111], v[110:111], v[158:159]
    v_cvt_pk_bf16_f32 v124, v104, v105
    v_cvt_pk_bf16_f32 v125, v106, v107
    v_cvt_pk_bf16_f32 v126, v108, v109
    v_cvt_pk_bf16_f32 v127, v110, v111
    buffer_store_dwordx4 v[124:127], v12, s[52:55], s15 offen offset:1024 sc0 sc1
    s_add_u32 s15, s15, 2048
    s_lshl_b32 s14, s6, 1
    s_add_u32 s14, s14, s8
    s_mul_i32 s14, s14, 8192
    s_add_u32 s14, s14, 3473408
    v_mul_u32_u24 v13, 1024, v0
    s_mov_b64 exec, 31
    s_waitcnt vmcnt(0)
    buffer_atomic_add v11, v13, s[52:55], s14 offen sc1
    s_mov_b64 exec, -1
    s_setprio 0
    s_mov_b64 exec, 1
    ds_add_u32 v15, v11 offset:4
    s_mov_b64 exec, -1
    s_cmp_lt_u32 s7, 5
    s_cbranch_scc1 L_s1
    s_endpgm
L_A:
    s_lshl_b32 s6, s4, 3
    s_add_u32 s6, s6, s5
    s_sub_u32 s6, s6, 22
    s_lshl_b32 s7, s4, 1
    s_add_u32 s7, s7, s5
    s_add_u32 s7, s7, 34
    s_cmp_ge_u32 s5, 30
    s_cselect_b32 s6, s7, s6
    s_and_b32 s4, s6, 7
    s_cmp_ge_u32 s6, 72
    s_cbranch_scc1 L_misc
    s_cmp_ge_u32 s3, 8
    s_cbranch_scc1 L_Au
    s_lshl_b32 s7, s6, 3
    s_add_u32 s7, s7, s3
    s_lshl_b32 s8, s7, 8
    v_lshlrev_b32 v2, 2, v0
    v_add_u32 v3, s8, v2
    s_lshl_b32 s8, s7, 1
    v_mov_b32 v4, s8
    s_waitcnt lgkmcnt(0)
    global_load_ushort v10, v4, s[26:27]
    global_load_dword v6, v3, s[18:19]
    global_load_dword v7, v3, s[20:21]
    global_load_dword v8, v3, s[22:23]
    global_load_dword v9, v3, s[24:25]
    global_load_ushort v11, v4, s[28:29]
    v_mov_b64 v[160:161], 0
    v_mov_b64 v[162:163], 0
    v_add_u32 v165, 155136, v2
    ds_write_b32 v165, v160
    s_waitcnt lgkmcnt(0)
    s_barrier
    s_setprio 2
    s_mul_i32 s9, s3, 8704
    s_mul_i32 s10, s3, 1536
    s_add_u32 s10, s10, 69632
    v_lshlrev_b32 v12, 3, v0
    v_add_u32 v12, s9, v12
    v_and_b32 v14, 15, v0
    v_lshrrev_b32 v15, 4, v0
    v_mul_u32_u24 v13, 544, v14
    v_lshl_add_u32 v13, v15, 4, v13
    v_add_u32 v13, s9, v13
    s_mov_b32 s12, 0x3fb8aa3b
    s_mov_b32 s13, 0xffff0000
    s_waitcnt vmcnt(5)
    v_lshlrev_b32 v10, 16, v10
    v_mul_f32 v10, s12, v10
    v_exp_f32 v10, v10
    s_waitcnt vmcnt(4)
    v_lshlrev_b32 v64, 16, v6
    v_and_b32 v65, s13, v6
    v_cvt_pk_bf16_f32 v10, v10, v10
    v_mul_f32 v64, s12, v64
    v_mul_f32 v65, s12, v65
    v_and_b32 v10, s13, v10
    v_exp_f32 v64, v64
    v_exp_f32 v65, v65
    s_waitcnt vmcnt(3)
    v_lshlrev_b32 v62, 16, v7
    v_and_b32 v63, s13, v7
    v_cvt_pk_bf16_f32 v64, v64, v65
    v_mul_f32 v62, v10, v62
    v_mul_f32 v63, v10, v63
    v_lshlrev_b32 v60, 16, v64
    v_and_b32 v61, s13, v64
    v_mul_f32 v62, 0.15915494, v62
    v_mul_f32 v63, 0.15915494, v63
    v_mul_f32 v60, v10, v60
    v_mul_f32 v61, v10, v61
    v_mul_f32 v60, 0xbfb8aa3b, v60
    v_mul_f32 v61, 0xbfb8aa3b, v61
    v_mul_f32 v64, 0x41000000, v60
    v_mul_f32 v66, 0x41000000, v62
    v_mul_f32 v65, 0x41000000, v61
    v_mul_f32 v67, 0x41000000, v63
    v_exp_f32 v64, v64
    v_fract_f32 v66, v66
    v_exp_f32 v65, v65
    v_fract_f32 v67, v67
    v_cos_f32 v28, v66
    v_sin_f32 v30, v66
    v_cos_f32 v29, v67
    v_sin_f32 v31, v67
    s_nop 0
    v_pk_mul_f32 v[28:29], v[28:29], v[64:65]
    v_pk_mul_f32 v[30:31], v[30:31], v[64:65]
    v_mov_b32 v78, 0x3f803f80
    v_mov_b32 v79, 0
    ds_write_b64 v12, v[78:79]
    v_cvt_pk_bf16_f32 v72, v28, v29
    v_cvt_pk_bf16_f32 v73, v30, v31
    ds_write_b64 v12, v[72:73] offset:544
    v_pk_mul_f32 v[20:21], v[28:29], v[28:29]
    v_pk_mul_f32 v[22:23], v[28:29], v[30:31]
    v_pk_fma_f32 v[20:21], v[30:31], v[30:31], v[20:21] neg_lo:[1,0,0] neg_hi:[1,0,0]
    v_pk_fma_f32 v[22:23], v[30:31], v[28:29], v[22:23]
    v_cvt_pk_bf16_f32 v74, v20, v21
    v_cvt_pk_bf16_f32 v75, v22, v23
    ds_write_b64 v12, v[74:75] offset:1088
    v_pk_mul_f32 v[48:49], v[28:29], v[20:21]
    v_pk_mul_f32 v[50:51], v[28:29], v[22:23]
    v_pk_fma_f32 v[48:49], v[30:31], v[22:23], v[48:49] neg_lo:[1,0,0] neg_hi:[1,0,0]
    v_pk_fma_f32 v[50:51], v[30:31], v[20:21], v[50:51]
    v_pk_mul_f32 v[56:57], v[20:21], v[20:21]
    v_pk_mul_f32 v[58:59], v[20:21], v[22:23]
    v_pk_fma_f32 v[56:57], v[22:23], v[22:23], v[56:57] neg_lo:[1,0,0] neg_hi:[1,0,0]
    v_pk_fma_f32 v[58:59], v[22:23], v[20:21], v[58:59]
    v_cvt_pk_bf16_f32 v76, v48, v49
    v_cvt_pk_bf16_f32 v77, v50, v51
    ds_write_b64 v12, v[76:77] offset:1632
    v_cvt_pk_bf16_f32 v78, v56, v57
    v_cvt_pk_bf16_f32 v79, v58, v59
    ds_write_b64 v12, v[78:79] offset:2176
    v_pk_mul_f32 v[44:45], v[48:49], v[20:21]
    v_pk_mul_f32 v[46:47], v[48:49], v[22:23]
    v_pk_fma_f32 v[44:45], v[50:51], v[22:23], v[44:45] neg_lo:[1,0,0] neg_hi:[1,0,0]
    v_pk_fma_f32 v[46:47], v[50:51], v[20:21], v[46:47]
    v_pk_mul_f32 v[52:53], v[56:57], v[20:21]
    v_pk_mul_f32 v[54:55], v[56:57], v[22:23]
    v_pk_fma_f32 v[52:53], v[58:59], v[22:23], v[52:53] neg_lo:[1,0,0] neg_hi:[1,0,0]
    v_pk_fma_f32 v[54:55], v[58:59], v[20:21], v[54:55]
    v_cvt_pk_bf16_f32 v72, v44, v45
    v_cvt_pk_bf16_f32 v73, v46, v47
    ds_write_b64 v12, v[72:73] offset:2720
    v_cvt_pk_bf16_f32 v74, v52, v53
    v_cvt_pk_bf16_f32 v75, v54, v55
    ds_write_b64 v12, v[74:75] offset:3264
    v_pk_mul_f32 v[48:49], v[44:45], v[20:21]
    v_pk_mul_f32 v[50:51], v[44:45], v[22:23]
    v_pk_fma_f32 v[48:49], v[46:47], v[22:23], v[48:49] neg_lo:[1,0,0] neg_hi:[1,0,0]
    v_pk_fma_f32 v[50:51], v[46:47], v[20:21], v[50:51]
    v_pk_mul_f32 v[56:57], v[52:53], v[20:21]
    v_pk_mul_f32 v[58:59], v[52:53], v[22:23]
    v_pk_fma_f32 v[56:57], v[54:55], v[22:23], v[56:57] neg_lo:[1,0,0] neg_hi:[1,0,0]
    v_pk_fma_f32 v[58:59], v[54:55], v[20:21], v[58:59]
    v_cvt_pk_bf16_f32 v76, v48, v49
    v_cvt_pk_bf16_f32 v77, v50, v51
    ds_write_b64 v12, v[76:77] offset:3808
    v_cvt_pk_bf16_f32 v78, v56, v57
    v_cvt_pk_bf16_f32 v79, v58, v59
    ds_write_b64 v12, v[78:79] offset:4352
    v_pk_mul_f32 v[44:45], v[48:49], v[20:21]
    v_pk_mul_f32 v[46:47], v[48:49], v[22:23]
    v_pk_fma_f32 v[44:45], v[50:51], v[22:23], v[44:45] neg_lo:[1,0,0] neg_hi:[1,0,0]
    v_pk_fma_f32 v[46:47], v[50:51], v[20:21], v[46:47]
    v_pk_mul_f32 v[52:53], v[56:57], v[20:21]
    v_pk_mul_f32 v[54:55], v[56:57], v[22:23]
    v_pk_fma_f32 v[52:53], v[58:59], v[22:23], v[52:53] neg_lo:[1,0,0] neg_hi:[1,0,0]
    v_pk_fma_f32 v[54:55], v[58:59], v[20:21], v[54:55]
    v_cvt_pk_bf16_f32 v72, v44, v45
    v_cvt_pk_bf16_f32 v73, v46, v47
    ds_write_b64 v12, v[72:73] offset:4896
    v_cvt_pk_bf16_f32 v74, v52, v53
    v_cvt_pk_bf16_f32 v75, v54, v55
    ds_write_b64 v12, v[74:75] offset:5440
    v_pk_mul_f32 v[48:49], v[44:45], v[20:21]
    v_pk_mul_f32 v[50:51], v[44:45], v[22:23]
    v_pk_fma_f32 v[48:49], v[46:47], v[22:23], v[48:49] neg_lo:[1,0,0] neg_hi:[1,0,0]
    v_pk_fma_f32 v[50:51], v[46:47], v[20:21], v[50:51]
    v_pk_mul_f32 v[56:57], v[52:53], v[20:21]
    v_pk_mul_f32 v[58:59], v[52:53], v[22:23]
    v_pk_fma_f32 v[56:57], v[54:55], v[22:23], v[56:57] neg_lo:[1,0,0] neg_hi:[1,0,0]
    v_pk_fma_f32 v[58:59], v[54:55], v[20:21], v[58:59]
    v_cvt_pk_bf16_f32 v76, v48, v49
    v_cvt_pk_bf16_f32 v77, v50, v51
    ds_write_b64 v12, v[76:77] offset:5984
    v_cvt_pk_bf16_f32 v78, v56, v57
    v_cvt_pk_bf16_f32 v79, v58, v59
    ds_write_b64 v12, v[78:79] offset:6528
    v_pk_mul_f32 v[44:45], v[48:49], v[20:21]
    v_pk_mul_f32 v[46:47], v[48:49], v[22:23]
    v_pk_fma_f32 v[44:45], v[50:51], v[22:23], v[44:45] neg_lo:[1,0,0] neg_hi:[1,0,0]
    v_pk_fma_f32 v[46:47], v[50:51], v[20:21], v[46:47]
    v_pk_mul_f32 v[52:53], v[56:57], v[20:21]
    v_pk_mul_f32 v[54:55], v[56:57], v[22:23]
    v_pk_fma_f32 v[52:53], v[58:59], v[22:23], v[52:53] neg_lo:[1,0,0] neg_hi:[1,0,0]
    v_pk_fma_f32 v[54:55], v[58:59], v[20:21], v[54:55]
    v_cvt_pk_bf16_f32 v72, v44, v45
    v_cvt_pk_bf16_f32 v73, v46, v47
    ds_write_b64 v12, v[72:73] offset:7072
    v_cvt_pk_bf16_f32 v74, v52, v53
    v_cvt_pk_bf16_f32 v75, v54, v55
    ds_write_b64 v12, v[74:75] offset:7616
    v_pk_mul_f32 v[48:49], v[44:45], v[20:21]
    v_pk_mul_f32 v[50:51], v[44:45], v[22:23]
    v_pk_fma_f32 v[48:49], v[46:47], v[22:23], v[48:49] neg_lo:[1,0,0] neg_hi:[1,0,0]
    v_pk_fma_f32 v[50:51], v[46:47], v[20:21], v[50:51]
    v_cvt_pk_bf16_f32 v76, v48, v49
    v_cvt_pk_bf16_f32 v77, v50, v51
    ds_write_b64 v12, v[76:77] offset:8160
    ds_read_b128 v[80:83], v13 offset:0
    ds_read_b128 v[84:87], v13 offset:64
    ds_read_b128 v[88:91], v13 offset:128
    ds_read_b128 v[92:95], v13 offset:192
    ds_read_b128 v[96:99], v13 offset:256
    ds_read_b128 v[100:103], v13 offset:320
    ds_read_b128 v[104:107], v13 offset:384
    ds_read_b128 v[108:111], v13 offset:448
    s_waitcnt vmcnt(0)
    v_mul_f32 v64, 0x3f800000, v60
    v_mul_f32 v66, 0xbf800000, v62
    v_mul_f32 v65, 0x3f800000, v61
    v_mul_f32 v67, 0xbf800000, v63
    v_exp_f32 v64, v64
    v_fract_f32 v66, v66
    v_exp_f32 v65, v65
    v_fract_f32 v67, v67
    v_cos_f32 v16, v66
    v_sin_f32 v18, v66
    v_cos_f32 v17, v67
    v_sin_f32 v19, v67
    s_nop 0
    v_pk_mul_f32 v[16:17], v[16:17], v[64:65]
    v_pk_mul_f32 v[18:19], v[18:19], v[64:65]
    v_mul_f32 v64, 0x43000000, v60
    v_mul_f32 v66, 0xc3000000, v62
    v_mul_f32 v65, 0x43000000, v61
    v_mul_f32 v67, 0xc3000000, v63
    v_exp_f32 v64, v64
    v_fract_f32 v66, v66
    v_exp_f32 v65, v65
    v_fract_f32 v67, v67
    v_cos_f32 v32, v66
    v_sin_f32 v34, v66
    v_cos_f32 v33, v67
    v_sin_f32 v35, v67
    s_nop 0
    v_pk_mul_f32 v[32:33], v[32:33], v[64:65]
    v_pk_mul_f32 v[34:35], v[34:35], v[64:65]
    v_add_f32 v10, v10, v10
    v_lshlrev_b32 v36, 16, v8
    v_and_b32 v37, s13, v8
    v_lshlrev_b32 v38, 16, v9
    v_and_b32 v39, s13, v9
    v_mul_f32 v36, v10, v36
    v_mul_f32 v37, v10, v37
    v_mul_f32 v38, -v10, v38
    v_mul_f32 v39, -v10, v39
    v_pk_mul_f32 v[40:41], v[36:37], v[32:33]
    v_pk_mul_f32 v[42:43], v[36:37], v[34:35]
    v_pk_fma_f32 v[40:41], v[38:39], v[34:35], v[40:41] neg_lo:[1,0,0] neg_hi:[1,0,0]
    v_pk_fma_f32 v[42:43], v[38:39], v[32:33], v[42:43]
    v_pk_mul_f32 v[20:21], v[16:17], v[16:17]
    v_pk_mul_f32 v[22:23], v[16:17], v[18:19]
    v_pk_fma_f32 v[20:21], v[18:19], v[18:19], v[20:21] neg_lo:[1,0,0] neg_hi:[1,0,0]
    v_pk_fma_f32 v[22:23], v[18:19], v[16:17], v[22:23]
    v_cvt_pk_bf16_f32 v78, v36, v37
    v_cvt_pk_bf16_f32 v79, v38, v39
    ds_write_b64 v12, v[78:79] offset:0
    v_cvt_pk_bf16_f32 v72, v40, v41
    v_cvt_pk_bf16_f32 v73, v42, v43
    ds_write_b64 v12, v[72:73] offset:4352
    v_pk_mul_f32 v[24:25], v[20:21], v[20:21]
    v_pk_mul_f32 v[26:27], v[20:21], v[22:23]
    v_pk_fma_f32 v[24:25], v[22:23], v[22:23], v[24:25] neg_lo:[1,0,0] neg_hi:[1,0,0]
    v_pk_fma_f32 v[26:27], v[22:23], v[20:21], v[26:27]
    v_pk_mul_f32 v[48:49], v[36:37], v[16:17]
    v_pk_mul_f32 v[50:51], v[36:37], v[18:19]
    v_pk_fma_f32 v[48:49], v[38:39], v[18:19], v[48:49] neg_lo:[1,0,0] neg_hi:[1,0,0]
    v_pk_fma_f32 v[50:51], v[38:39], v[16:17], v[50:51]
    v_pk_mul_f32 v[56:57], v[40:41], v[16:17]
    v_pk_mul_f32 v[58:59], v[40:41], v[18:19]
    v_pk_fma_f32 v[56:57], v[42:43], v[18:19], v[56:57] neg_lo:[1,0,0] neg_hi:[1,0,0]
    v_pk_fma_f32 v[58:59], v[42:43], v[16:17], v[58:59]
    v_cvt_pk_bf16_f32 v74, v48, v49
    v_cvt_pk_bf16_f32 v75, v50, v51
    ds_write_b64 v12, v[74:75] offset:544
    v_cvt_pk_bf16_f32 v76, v56, v57
    v_cvt_pk_bf16_f32 v77, v58, v59
    ds_write_b64 v12, v[76:77] offset:4896
    v_pk_mul_f32 v[44:45], v[48:49], v[16:17]
    v_pk_mul_f32 v[46:47], v[48:49], v[18:19]
    v_pk_fma_f32 v[44:45], v[50:51], v[18:19], v[44:45] neg_lo:[1,0,0] neg_hi:[1,0,0]
    v_pk_fma_f32 v[46:47], v[50:51], v[16:17], v[46:47]
    v_pk_mul_f32 v[52:53], v[56:57], v[16:17]
    v_pk_mul_f32 v[54:55], v[56:57], v[18:19]
    v_pk_fma_f32 v[52:53], v[58:59], v[18:19], v[52:53] neg_lo:[1,0,0] neg_hi:[1,0,0]
    v_pk_fma_f32 v[54:55], v[58:59], v[16:17], v[54:55]
    v_cvt_pk_bf16_f32 v78, v44, v45
    v_cvt_pk_bf16_f32 v79, v46, v47
    ds_write_b64 v12, v[78:79] offset:1088
    v_cvt_pk_bf16_f32 v72, v52, v53
    v_cvt_pk_bf16_f32 v73, v54, v55
    ds_write_b64 v12, v[72:73] offset:5440
    v_pk_mul_f32 v[48:49], v[44:45], v[16:17]
    v_pk_mul_f32 v[50:51], v[44:45], v[18:19]
    v_pk_fma_f32 v[48:49], v[46:47], v[18:19], v[48:49] neg_lo:[1,0,0] neg_hi:[1,0,0]
    v_pk_fma_f32 v[50:51], v[46:47], v[16:17], v[50:51]
    v_pk_mul_f32 v[56:57], v[52:53], v[16:17]
    v_pk_mul_f32 v[58:59], v[52:53], v[18:19]
    v_pk_fma_f32 v[56:57], v[54:55], v[18:19], v[56:57] neg_lo:[1,0,0] neg_hi:[1,0,0]
    v_pk_fma_f32 v[58:59], v[54:55], v[16:17], v[58:59]
    v_cvt_pk_bf16_f32 v74, v48, v49
    v_cvt_pk_bf16_f32 v75, v50, v51
    ds_write_b64 v12, v[74:75] offset:1632
    v_cvt_pk_bf16_f32 v76, v56, v57
    v_cvt_pk_bf16_f32 v77, v58, v59
    ds_write_b64 v12, v[76:77] offset:5984
    v_pk_mul_f32 v[44:45], v[48:49], v[16:17]
    v_pk_mul_f32 v[46:47], v[48:49], v[18:19]
    v_pk_fma_f32 v[44:45], v[50:51], v[18:19], v[44:45] neg_lo:[1,0,0] neg_hi:[1,0,0]
    v_pk_fma_f32 v[46:47], v[50:51], v[16:17], v[46:47]
    v_pk_mul_f32 v[52:53], v[56:57], v[16:17]
    v_pk_mul_f32 v[54:55], v[56:57], v[18:19]
    v_pk_fma_f32 v[52:53], v[58:59], v[18:19], v[52:53] neg_lo:[1,0,0] neg_hi:[1,0,0]
    v_pk_fma_f32 v[54:55], v[58:59], v[16:17], v[54:55]
    v_cvt_pk_bf16_f32 v78, v44, v45
    v_cvt_pk_bf16_f32 v79, v46, v47
    ds_write_b64 v12, v[78:79] offset:2176
    v_cvt_pk_bf16_f32 v72, v52, v53
    v_cvt_pk_bf16_f32 v73, v54, v55
    ds_write_b64 v12, v[72:73] offset:6528
    v_pk_mul_f32 v[48:49], v[44:45], v[16:17]
    v_pk_mul_f32 v[50:51], v[44:45], v[18:19]
    v_pk_fma_f32 v[48:49], v[46:47], v[18:19], v[48:49] neg_lo:[1,0,0] neg_hi:[1,0,0]
    v_pk_fma_f32 v[50:51], v[46:47], v[16:17], v[50:51]
    v_pk_mul_f32 v[56:57], v[52:53], v[16:17]
    v_pk_mul_f32 v[58:59], v[52:53], v[18:19]
    v_pk_fma_f32 v[56:57], v[54:55], v[18:19], v[56:57] neg_lo:[1,0,0] neg_hi:[1,0,0]
    v_pk_fma_f32 v[58:59], v[54:55], v[16:17], v[58:59]
    v_cvt_pk_bf16_f32 v74, v48, v49
    v_cvt_pk_bf16_f32 v75, v50, v51
    ds_write_b64 v12, v[74:75] offset:2720
    v_cvt_pk_bf16_f32 v76, v56, v57
    v_cvt_pk_bf16_f32 v77, v58, v59
    ds_write_b64 v12, v[76:77] offset:7072
    v_pk_mul_f32 v[44:45], v[48:49], v[16:17]
    v_pk_mul_f32 v[46:47], v[48:49], v[18:19]
    v_pk_fma_f32 v[44:45], v[50:51], v[18:19], v[44:45] neg_lo:[1,0,0] neg_hi:[1,0,0]
    v_pk_fma_f32 v[46:47], v[50:51], v[16:17], v[46:47]
    v_pk_mul_f32 v[52:53], v[56:57], v[16:17]
    v_pk_mul_f32 v[54:55], v[56:57], v[18:19]
    v_pk_fma_f32 v[52:53], v[58:59], v[18:19], v[52:53] neg_lo:[1,0,0] neg_hi:[1,0,0]
    v_pk_fma_f32 v[54:55], v[58:59], v[16:17], v[54:55]
    v_cvt_pk_bf16_f32 v78, v44, v45
    v_cvt_pk_bf16_f32 v79, v46, v47
    ds_write_b64 v12, v[78:79] offset:3264
    v_cvt_pk_bf16_f32 v72, v52, v53
    v_cvt_pk_bf16_f32 v73, v54, v55
    ds_write_b64 v12, v[72:73] offset:7616
    v_pk_mul_f32 v[48:49], v[44:45], v[16:17]
    v_pk_mul_f32 v[50:51], v[44:45], v[18:19]
    v_pk_fma_f32 v[48:49], v[46:47], v[18:19], v[48:49] neg_lo:[1,0,0] neg_hi:[1,0,0]
    v_pk_fma_f32 v[50:51], v[46:47], v[16:17], v[50:51]
    v_pk_mul_f32 v[56:57], v[52:53], v[16:17]
    v_pk_mul_f32 v[58:59], v[52:53], v[18:19]
    v_pk_fma_f32 v[56:57], v[54:55], v[18:19], v[56:57] neg_lo:[1,0,0] neg_hi:[1,0,0]
    v_pk_fma_f32 v[58:59], v[54:55], v[16:17], v[58:59]
    v_cvt_pk_bf16_f32 v74, v48, v49
    v_cvt_pk_bf16_f32 v75, v50, v51
    ds_write_b64 v12, v[74:75] offset:3808
    v_cvt_pk_bf16_f32 v76, v56, v57
    v_cvt_pk_bf16_f32 v77, v58, v59
    ds_write_b64 v12, v[76:77] offset:8160
    ds_read_b128 v[112:115], v13 offset:0
    ds_read_b128 v[116:119], v13 offset:64
    ds_read_b128 v[120:123], v13 offset:128
    ds_read_b128 v[124:127], v13 offset:192
    ds_read_b128 v[128:131], v13 offset:256
    ds_read_b128 v[132:135], v13 offset:320
    ds_read_b128 v[136:139], v13 offset:384
    ds_read_b128 v[140:143], v13 offset:448
    v_pk_mul_f32 v[36:37], v[40:41], v[32:33]
    v_pk_mul_f32 v[38:39], v[40:41], v[34:35]
    v_pk_fma_f32 v[36:37], v[42:43], v[34:35], v[36:37] neg_lo:[1,0,0] neg_hi:[1,0,0]
    v_pk_fma_f32 v[38:39], v[42:43], v[32:33], v[38:39]
    v_pk_mul_f32 v[40:41], v[36:37], v[32:33]
    v_pk_mul_f32 v[42:43], v[36:37], v[34:35]
    v_pk_fma_f32 v[40:41], v[38:39], v[34:35], v[40:41] neg_lo:[1,0,0] neg_hi:[1,0,0]
    v_pk_fma_f32 v[42:43], v[38:39], v[32:33], v[42:43]
    v_cvt_pk_bf16_f32 v78, v36, v37
    v_cvt_pk_bf16_f32 v79, v38, v39
    ds_write_b64 v12, v[78:79] offset:0
    v_cvt_pk_bf16_f32 v72, v40, v41
    v_cvt_pk_bf16_f32 v73, v42, v43
    ds_write_b64 v12, v[72:73] offset:2176
    v_pk_mul_f32 v[48:49], v[36:37], v[20:21]
    v_pk_mul_f32 v[50:51], v[36:37], v[22:23]
    v_pk_fma_f32 v[48:49], v[38:39], v[22:23], v[48:49] neg_lo:[1,0,0] neg_hi:[1,0,0]
    v_pk_fma_f32 v[50:51], v[38:39], v[20:21], v[50:51]
    v_pk_mul_f32 v[56:57], v[40:41], v[20:21]
    v_pk_mul_f32 v[58:59], v[40:41], v[22:23]
    v_pk_fma_f32 v[56:57], v[42:43], v[22:23], v[56:57] neg_lo:[1,0,0] neg_hi:[1,0,0]
    v_pk_fma_f32 v[58:59], v[42:43], v[20:21], v[58:59]
    v_cvt_pk_bf16_f32 v74, v48, v49
    v_cvt_pk_bf16_f32 v75, v50, v51
    ds_write_b64 v12, v[74:75] offset:544
    v_cvt_pk_bf16_f32 v76, v56, v57
    v_cvt_pk_bf16_f32 v77, v58, v59
    ds_write_b64 v12, v[76:77] offset:2720
    v_pk_mul_f32 v[44:45], v[48:49], v[20:21]
    v_pk_mul_f32 v[46:47], v[48:49], v[22:23]
    v_pk_fma_f32 v[44:45], v[50:51], v[22:23], v[44:45] neg_lo:[1,0,0] neg_hi:[1,0,0]
    v_pk_fma_f32 v[46:47], v[50:51], v[20:21], v[46:47]
    v_pk_mul_f32 v[52:53], v[56:57], v[20:21]
    v_pk_mul_f32 v[54:55], v[56:57], v[22:23]
    v_pk_fma_f32 v[52:53], v[58:59], v[22:23], v[52:53] neg_lo:[1,0,0] neg_hi:[1,0,0]
    v_pk_fma_f32 v[54:55], v[58:59], v[20:21], v[54:55]
    v_cvt_pk_bf16_f32 v78, v44, v45
    v_cvt_pk_bf16_f32 v79, v46, v47
    ds_write_b64 v12, v[78:79] offset:1088
    v_cvt_pk_bf16_f32 v72, v52, v53
    v_cvt_pk_bf16_f32 v73, v54, v55
    ds_write_b64 v12, v[72:73] offset:3264
    v_pk_mul_f32 v[48:49], v[44:45], v[20:21]
    v_pk_mul_f32 v[50:51], v[44:45], v[22:23]
    v_pk_fma_f32 v[48:49], v[46:47], v[22:23], v[48:49] neg_lo:[1,0,0] neg_hi:[1,0,0]
    v_pk_fma_f32 v[50:51], v[46:47], v[20:21], v[50:51]
    v_pk_mul_f32 v[56:57], v[52:53], v[20:21]
    v_pk_mul_f32 v[58:59], v[52:53], v[22:23]
    v_pk_fma_f32 v[56:57], v[54:55], v[22:23], v[56:57] neg_lo:[1,0,0] neg_hi:[1,0,0]
    v_pk_fma_f32 v[58:59], v[54:55], v[20:21], v[58:59]
    v_cvt_pk_bf16_f32 v74, v48, v49
    v_cvt_pk_bf16_f32 v75, v50, v51
    ds_write_b64 v12, v[74:75] offset:1632
    v_cvt_pk_bf16_f32 v76, v56, v57
    v_cvt_pk_bf16_f32 v77, v58, v59
    ds_write_b64 v12, v[76:77] offset:3808
    s_waitcnt lgkmcnt(8)
    v_mfma_f32_16x16x32_bf16 v[144:147], v[112:115], v[80:83], 0
    v_mfma_f32_16x16x32_bf16 v[144:147], v[116:119], v[84:87], v[144:147]
    v_mfma_f32_16x16x32_bf16 v[144:147], v[120:123], v[88:91], v[144:147]
    v_mfma_f32_16x16x32_bf16 v[144:147], v[124:127], v[92:95], v[144:147]
    v_mfma_f32_16x16x32_bf16 v[144:147], v[128:131], v[96:99], v[144:147]
    v_mfma_f32_16x16x32_bf16 v[144:147], v[132:135], v[100:103], v[144:147]
    v_mfma_f32_16x16x32_bf16 v[144:147], v[136:139], v[104:107], v[144:147]
    v_mfma_f32_16x16x32_bf16 v[144:147], v[140:143], v[108:111], v[144:147]
    v_pk_mul_f32 v[36:37], v[40:41], v[32:33]
    v_pk_mul_f32 v[38:39], v[40:41], v[34:35]
    v_pk_fma_f32 v[36:37], v[42:43], v[34:35], v[36:37] neg_lo:[1,0,0] neg_hi:[1,0,0]
    v_pk_fma_f32 v[38:39], v[42:43], v[32:33], v[38:39]
    v_pk_mul_f32 v[44:45], v[36:37], v[24:25]
    v_pk_mul_f32 v[46:47], v[36:37], v[26:27]
    v_pk_fma_f32 v[44:45], v[38:39], v[26:27], v[44:45] neg_lo:[1,0,0] neg_hi:[1,0,0]
    v_pk_fma_f32 v[46:47], v[38:39], v[24:25], v[46:47]
    v_cvt_pk_bf16_f32 v78, v36, v37
    v_cvt_pk_bf16_f32 v79, v38, v39
    ds_write_b64 v12, v[78:79] offset:4352
    v_cvt_pk_bf16_f32 v72, v44, v45
    v_cvt_pk_bf16_f32 v73, v46, v47
    ds_write_b64 v12, v[72:73] offset:4896
    v_pk_mul_f32 v[40:41], v[36:37], v[32:33]
    v_pk_mul_f32 v[42:43], v[36:37], v[34:35]
    v_pk_fma_f32 v[40:41], v[38:39], v[34:35], v[40:41] neg_lo:[1,0,0] neg_hi:[1,0,0]
    v_pk_fma_f32 v[42:43], v[38:39], v[32:33], v[42:43]
    v_pk_mul_f32 v[48:49], v[40:41], v[24:25]
    v_pk_mul_f32 v[50:51], v[40:41], v[26:27]
    v_pk_fma_f32 v[48:49], v[42:43], v[26:27], v[48:49] neg_lo:[1,0,0] neg_hi:[1,0,0]
    v_pk_fma_f32 v[50:51], v[42:43], v[24:25], v[50:51]
    v_cvt_pk_bf16_f32 v74, v40, v41
    v_cvt_pk_bf16_f32 v75, v42, v43
    ds_write_b64 v12, v[74:75] offset:5440
    v_cvt_pk_bf16_f32 v76, v48, v49
    v_cvt_pk_bf16_f32 v77, v50, v51
    ds_write_b64 v12, v[76:77] offset:5984
    v_pk_mul_f32 v[36:37], v[40:41], v[32:33]
    v_pk_mul_f32 v[38:39], v[40:41], v[34:35]
    v_pk_fma_f32 v[36:37], v[42:43], v[34:35], v[36:37] neg_lo:[1,0,0] neg_hi:[1,0,0]
    v_pk_fma_f32 v[38:39], v[42:43], v[32:33], v[38:39]
    v_pk_mul_f32 v[44:45], v[36:37], v[24:25]
    v_pk_mul_f32 v[46:47], v[36:37], v[26:27]
    v_pk_fma_f32 v[44:45], v[38:39], v[26:27], v[44:45] neg_lo:[1,0,0] neg_hi:[1,0,0]
    v_pk_fma_f32 v[46:47], v[38:39], v[24:25], v[46:47]
    v_cvt_pk_bf16_f32 v78, v36, v37
    v_cvt_pk_bf16_f32 v79, v38, v39
    ds_write_b64 v12, v[78:79] offset:6528
    v_cvt_pk_bf16_f32 v72, v44, v45
    v_cvt_pk_bf16_f32 v73, v46, v47
    ds_write_b64 v12, v[72:73] offset:7072
    v_pk_mul_f32 v[40:41], v[36:37], v[32:33]
    v_pk_mul_f32 v[42:43], v[36:37], v[34:35]
    v_pk_fma_f32 v[40:41], v[38:39], v[34:35], v[40:41] neg_lo:[1,0,0] neg_hi:[1,0,0]
    v_pk_fma_f32 v[42:43], v[38:39], v[32:33], v[42:43]
    v_pk_mul_f32 v[48:49], v[40:41], v[24:25]
    v_pk_mul_f32 v[50:51], v[40:41], v[26:27]
    v_pk_fma_f32 v[48:49], v[42:43], v[26:27], v[48:49] neg_lo:[1,0,0] neg_hi:[1,0,0]
    v_pk_fma_f32 v[50:51], v[42:43], v[24:25], v[50:51]
    v_cvt_pk_bf16_f32 v74, v40, v41
    v_cvt_pk_bf16_f32 v75, v42, v43
    ds_write_b64 v12, v[74:75] offset:7616
    v_cvt_pk_bf16_f32 v76, v48, v49
    v_cvt_pk_bf16_f32 v77, v50, v51
    ds_write_b64 v12, v[76:77] offset:8160
    ds_read_b128 v[112:115], v13 offset:0
    ds_read_b128 v[116:119], v13 offset:64
    ds_read_b128 v[120:123], v13 offset:128
    ds_read_b128 v[124:127], v13 offset:192
    ds_read_b128 v[128:131], v13 offset:256
    ds_read_b128 v[132:135], v13 offset:320
    ds_read_b128 v[136:139], v13 offset:384
    ds_read_b128 v[140:143], v13 offset:448
    v_pk_mul_f32 v[36:37], v[40:41], v[32:33]
    v_pk_mul_f32 v[38:39], v[40:41], v[34:35]
    v_pk_fma_f32 v[36:37], v[42:43], v[34:35], v[36:37] neg_lo:[1,0,0] neg_hi:[1,0,0]
    v_pk_fma_f32 v[38:39], v[42:43], v[32:33], v[38:39]
    v_cvt_pk_bf16_f32 v78, v36, v37
    v_cvt_pk_bf16_f32 v79, v38, v39
    ds_write_b64 v12, v[78:79] offset:0
    v_pk_mul_f32 v[40:41], v[36:37], v[32:33]
    v_pk_mul_f32 v[42:43], v[36:37], v[34:35]
    v_pk_fma_f32 v[40:41], v[38:39], v[34:35], v[40:41] neg_lo:[1,0,0] neg_hi:[1,0,0]
    v_pk_fma_f32 v[42:43], v[38:39], v[32:33], v[42:43]
    v_cvt_pk_bf16_f32 v72, v40, v41
    v_cvt_pk_bf16_f32 v73, v42, v43
    ds_write_b64 v12, v[72:73] offset:544
    v_pk_mul_f32 v[36:37], v[40:41], v[32:33]
    v_pk_mul_f32 v[38:39], v[40:41], v[34:35]
    v_pk_fma_f32 v[36:37], v[42:43], v[34:35], v[36:37] neg_lo:[1,0,0] neg_hi:[1,0,0]
    v_pk_fma_f32 v[38:39], v[42:43], v[32:33], v[38:39]
    v_cvt_pk_bf16_f32 v74, v36, v37
    v_cvt_pk_bf16_f32 v75, v38, v39
    ds_write_b64 v12, v[74:75] offset:1088
    v_pk_mul_f32 v[40:41], v[36:37], v[32:33]
    v_pk_mul_f32 v[42:43], v[36:37], v[34:35]
    v_pk_fma_f32 v[40:41], v[38:39], v[34:35], v[40:41] neg_lo:[1,0,0] neg_hi:[1,0,0]
    v_pk_fma_f32 v[42:43], v[38:39], v[32:33], v[42:43]
    v_cvt_pk_bf16_f32 v76, v40, v41
    v_cvt_pk_bf16_f32 v77, v42, v43
    ds_write_b64 v12, v[76:77] offset:1632
    s_waitcnt lgkmcnt(4)
    v_mfma_f32_16x16x32_bf16 v[148:151], v[112:115], v[80:83], 0
    v_mfma_f32_16x16x32_bf16 v[148:151], v[116:119], v[84:87], v[148:151]
    v_mfma_f32_16x16x32_bf16 v[148:151], v[120:123], v[88:91], v[148:151]
    v_mfma_f32_16x16x32_bf16 v[148:151], v[124:127], v[92:95], v[148:151]
    v_mfma_f32_16x16x32_bf16 v[148:151], v[128:131], v[96:99], v[148:151]
    v_mfma_f32_16x16x32_bf16 v[148:151], v[132:135], v[100:103], v[148:151]
    v_mfma_f32_16x16x32_bf16 v[148:151], v[136:139], v[104:107], v[148:151]
    v_mfma_f32_16x16x32_bf16 v[148:151], v[140:143], v[108:111], v[148:151]
    v_pk_mul_f32 v[36:37], v[40:41], v[32:33]
    v_pk_mul_f32 v[38:39], v[40:41], v[34:35]
    v_pk_fma_f32 v[36:37], v[42:43], v[34:35], v[36:37] neg_lo:[1,0,0] neg_hi:[1,0,0]
    v_pk_fma_f32 v[38:39], v[42:43], v[32:33], v[38:39]
    v_cvt_pk_bf16_f32 v78, v36, v37
    v_cvt_pk_bf16_f32 v79, v38, v39
    ds_write_b64 v12, v[78:79] offset:2176
    v_pk_mul_f32 v[40:41], v[36:37], v[32:33]
    v_pk_mul_f32 v[42:43], v[36:37], v[34:35]
    v_pk_fma_f32 v[40:41], v[38:39], v[34:35], v[40:41] neg_lo:[1,0,0] neg_hi:[1,0,0]
    v_pk_fma_f32 v[42:43], v[38:39], v[32:33], v[42:43]
    v_cvt_pk_bf16_f32 v72, v40, v41
    v_cvt_pk_bf16_f32 v73, v42, v43
    ds_write_b64 v12, v[72:73] offset:2720
    v_pk_mul_f32 v[36:37], v[40:41], v[32:33]
    v_pk_mul_f32 v[38:39], v[40:41], v[34:35]
    v_pk_fma_f32 v[36:37], v[42:43], v[34:35], v[36:37] neg_lo:[1,0,0] neg_hi:[1,0,0]
    v_pk_fma_f32 v[38:39], v[42:43], v[32:33], v[38:39]
    v_cvt_pk_bf16_f32 v74, v36, v37
    v_cvt_pk_bf16_f32 v75, v38, v39
    ds_write_b64 v12, v[74:75] offset:3264
    v_pk_mul_f32 v[40:41], v[36:37], v[32:33]
    v_pk_mul_f32 v[42:43], v[36:37], v[34:35]
    v_pk_fma_f32 v[40:41], v[38:39], v[34:35], v[40:41] neg_lo:[1,0,0] neg_hi:[1,0,0]
    v_pk_fma_f32 v[42:43], v[38:39], v[32:33], v[42:43]
    v_cvt_pk_bf16_f32 v76, v40, v41
    v_cvt_pk_bf16_f32 v77, v42, v43
    ds_write_b64 v12, v[76:77] offset:3808
    v_pk_mul_f32 v[36:37], v[40:41], v[32:33]
    v_pk_mul_f32 v[38:39], v[40:41], v[34:35]
    v_pk_fma_f32 v[36:37], v[42:43], v[34:35], v[36:37] neg_lo:[1,0,0] neg_hi:[1,0,0]
    v_pk_fma_f32 v[38:39], v[42:43], v[32:33], v[38:39]
    v_cvt_pk_bf16_f32 v78, v36, v37
    v_cvt_pk_bf16_f32 v79, v38, v39
    ds_write_b64 v12, v[78:79] offset:4352
    ds_read_b128 v[112:115], v13 offset:0
    ds_read_b128 v[116:119], v13 offset:64
    ds_read_b128 v[120:123], v13 offset:128
    ds_read_b128 v[124:127], v13 offset:192
    ds_read_b128 v[128:131], v13 offset:256
    ds_read_b128 v[132:135], v13 offset:320
    ds_read_b128 v[136:139], v13 offset:384
    ds_read_b128 v[140:143], v13 offset:448
    v_lshrrev_b32 v16, 1, v15
    v_lshlrev_b32 v16, 8, v16
    v_lshl_add_u32 v16, v14, 4, v16
    v_and_b32 v17, 1, v15
    v_lshl_add_u32 v16, v17, 3, v16
    v_add_u32 v16, s10, v16
    v_cmp_gt_u32 vcc, 2, v15
    v_lshlrev_b32 v17, 2, v14
    v_lshlrev_b32 v18, 3, v14
    v_cndmask_b32 v17, v17, v18, vcc
    v_lshl_add_u32 v17, v15, 7, v17
    v_add_u32 v17, s10, v17
    v_cndmask_b32 v18, 64, 4, vcc
    v_add_u32 v18, v17, v18
    v_lshlrev_b32 v19, 5, v14
    v_lshl_add_u32 v19, v15, 3, v19
    v_add_u32 v19, s10, v19
    v_lshlrev_b32 v11, 16, v11
    s_mov_b64 exec, 1
    v_add_f32 v144, v144, v11
    s_mov_b64 exec, -1
    v_cvt_pk_bf16_f32 v20, v144, v145
    v_cvt_pk_bf16_f32 v21, v146, v147
    v_cvt_pk_bf16_f32 v22, v148, v149
    v_cvt_pk_bf16_f32 v23, v150, v151
    ds_write_b64 v16, v[20:21]
    ds_write_b32 v17, v22 offset:512
    ds_write_b32 v18, v23 offset:512
    s_waitcnt lgkmcnt(3)
    v_mfma_f32_16x16x32_bf16 v[152:155], v[80:83], v[112:115], 0
    v_mfma_f32_16x16x32_bf16 v[152:155], v[84:87], v[116:119], v[152:155]
    v_mfma_f32_16x16x32_bf16 v[152:155], v[88:91], v[120:123], v[152:155]
    v_mfma_f32_16x16x32_bf16 v[152:155], v[92:95], v[124:127], v[152:155]
    v_mfma_f32_16x16x32_bf16 v[152:155], v[96:99], v[128:131], v[152:155]
    v_mfma_f32_16x16x32_bf16 v[152:155], v[100:103], v[132:135], v[152:155]
    v_mfma_f32_16x16x32_bf16 v[152:155], v[104:107], v[136:139], v[152:155]
    v_mfma_f32_16x16x32_bf16 v[152:155], v[108:111], v[140:143], v[152:155]
    v_cmp_gt_u32 vcc, 32, v0
    v_lshlrev_b32 v26, 4, v0
    v_lshlrev_b32 v27, 3, v0
    v_add_u32 v27, 256, v27
    v_cndmask_b32 v27, v27, v26, vcc
    v_add_u32 v27, s10, v27
    v_add_u32 v28, s10, v2
    v_lshrrev_b32 v29, 1, v0
    v_lshlrev_b32 v29, 2, v29
    v_add_u32 v29, s10, v29
    v_add_u32 v29, 1024, v29
    v_and_b32 v30, 1, v0
    v_sub_u32 v30, 0, v30
    s_mov_b32 s14, 0x01000100
    s_mov_b32 s15, 0x03020302
    v_and_b32 v31, 0x02020202, v30
    v_and_b32 v32, 0x02020404, v30
    v_add_u32 v33, s15, v31
    v_add_u32 v31, s14, v31
    v_add_u32 v32, 0x03020100, v32
    v_cvt_pk_bf16_f32 v24, v152, v153
    v_cvt_pk_bf16_f32 v25, v154, v155
    ds_write_b64 v19, v[24:25] offset:1024
    ds_read_b64 v[40:41], v27
    ds_read_b64 v[42:43], v27 offset:8
    ds_read2_b32 v[44:45], v28 offset0:192 offset1:193
    ds_read2_b32 v[46:47], v29 offset0:0 offset1:1
    ds_read2_b32 v[48:49], v29 offset0:32 offset1:33
    v_add_u32 v34, s9, v2
    v_mov_b32 v35, 0
    s_mov_b64 exec, 0xffff
    ds_write_b32 v34, v35 offset:0
    ds_write_b32 v34, v35 offset:4228
    s_mov_b64 exec, -1
    v_add_u32 v26, s9, v26
    s_mov_b32 exec_lo, 0
    s_waitcnt lgkmcnt(5)
    v_alignbyte_b32 v43, v42, v41, 2
    v_perm_b32 v42, v41, v41, s14
    v_alignbyte_b32 v41, v41, v40, 2
    v_perm_b32 v40, v40, v40, s14
    s_mov_b64 exec, -1
    s_waitcnt lgkmcnt(2)
    v_perm_b32 v52, v44, v44, s14
    v_mov_b32 v53, v44
    v_perm_b32 v54, v44, v44, s15
    v_perm_b32 v55, v45, v45, s14
    v_perm_b32 v56, v47, v46, v31
    v_perm_b32 v57, v47, v46, v31
    v_perm_b32 v58, v47, v46, v32
    v_perm_b32 v59, v47, v46, v33
    v_perm_b32 v60, v49, v48, v31
    v_perm_b32 v61, v49, v48, v31
    v_perm_b32 v62, v49, v48, v32
    v_perm_b32 v63, v49, v48, v33
    ds_write_b128 v26, v[40:43] offset:64
    ds_write_b32 v26, v40 offset:4292
    ds_write_b32 v26, v41 offset:4296
    ds_write_b32 v26, v42 offset:4300
    ds_write_b32 v26, v43 offset:4304
    ds_write_b128 v26, v[52:55] offset:1088
    ds_write_b32 v26, v52 offset:5316
    ds_write_b32 v26, v53 offset:5320
    ds_write_b32 v26, v54 offset:5324
    ds_write_b32 v26, v55 offset:5328
    ds_write_b128 v26, v[56:59] offset:2112
    ds_write_b32 v26, v56 offset:6340
    ds_write_b32 v26, v57 offset:6344
    ds_write_b32 v26, v58 offset:6348
    ds_write_b32 v26, v59 offset:6352
    ds_write_b128 v26, v[60:63] offset:3136
    ds_write_b32 v26, v60 offset:7364
    ds_write_b32 v26, v61 offset:7368
    ds_write_b32 v26, v62 offset:7372
    ds_write_b32 v26, v63 offset:7376
    v_lshl_add_u32 v3, v15, 2, v14
    v_lshlrev_b32 v3, 2, v3
    v_and_b32 v4, 4228, v30
    v_sub_u32 v3, v3, v4
    s_add_u32 s14, s9, 4232
    v_add_u32 v3, s14, v3
    v_bfe_u32 v5, v0, 3, 1
    v_bfe_u32 v6, v0, 2, 1
    v_xor_b32 v6, v6, v5
    v_and_b32 v7, 3, v0
    v_lshl_add_u32 v6, v6, 2, v7
    v_sub_u32 v6, 7, v6
    v_mul_u32_u24 v4, 4576, v5
    v_lshl_add_u32 v4, v6, 6, v4
    v_lshl_add_u32 v4, v15, 4, v4
    s_mul_i32 s14, s3, 9152
    s_add_u32 s14, s14, 81920
    v_add_u32 v4, s14, v4
    v_cmp_le_u32 vcc, 28, v0
    v_mov_b32 v8, 4128
    s_nop 0
    v_cndmask_b32 v7, 0, v8, vcc
    v_lshl_add_u32 v7, v0, 4, v7
    v_add_u32 v7, s14, v7
    s_mov_b32 exec_hi, 0xffffff
    ds_write_b128 v7, v[160:163] offset:4096
    s_mov_b64 exec, -1
    v_mov_b32 v15, 155136
    v_mov_b32 v11, 1
    s_and_b32 s14, s3, 3
    s_lshl_b32 s14, s14, 6
    v_add_u32 v12, s14, v12
    s_cmp_ge_u32 s3, 4
    s_cbranch_scc1 L_cp
    s_setprio 1
L_cp:
    ds_read_b64 v[52:53], v3 offset:0
    ds_read_b64 v[54:55], v3 offset:8
    s_mov_b32 s59, 0
    s_branch WI19
WL19:
    s_sleep 1
WI19:
    ds_read_b32 v14, v15 offset:16
    s_add_u32 s59, s59, 1
    s_waitcnt lgkmcnt(0)
    v_cmp_gt_u32 vcc, 2, v14
    s_cmp_ge_u32 s59, 524288
    s_cbranch_scc1 WX19
    s_nop 2
    s_cbranch_vccnz WL19
WX19:
    ds_read_b128 v[56:59], v4 offset:3584
    ds_read_b128 v[60:63], v4 offset:3072
    ds_read_b128 v[64:67], v4 offset:2560
    ds_read_b128 v[68:71], v4 offset:2048
    ds_read_b64 v[72:73], v3 offset:512
    ds_read_b64 v[74:75], v3 offset:520
    ds_read_b64 v[76:77], v3 offset:1024
    ds_read_b64 v[78:79], v3 offset:1032
    ds_read_b64 v[80:81], v3 offset:1536
    ds_read_b64 v[82:83], v3 offset:1544
    s_waitcnt lgkmcnt(9)
    v_mfma_f32_16x16x32_bf16 v[16:19], v[52:55], v[56:59], 0
    s_waitcnt lgkmcnt(8)
    v_mfma_f32_16x16x32_bf16 v[20:23], v[52:55], v[60:63], 0
    s_waitcnt lgkmcnt(7)
    v_mfma_f32_16x16x32_bf16 v[24:27], v[52:55], v[64:67], 0
    s_waitcnt lgkmcnt(6)
    v_mfma_f32_16x16x32_bf16 v[28:31], v[52:55], v[68:71], 0
    s_waitcnt lgkmcnt(4)
    v_mfma_f32_16x16x32_bf16 v[20:23], v[72:75], v[56:59], v[20:23]
    v_mfma_f32_16x16x32_bf16 v[24:27], v[72:75], v[60:63], v[24:27]
    ds_read_b64 v[84:85], v3 offset:2048
    ds_read_b64 v[86:87], v3 offset:2056
    v_mfma_f32_16x16x32_bf16 v[28:31], v[72:75], v[64:67], v[28:31]
    v_mfma_f32_16x16x32_bf16 v[32:35], v[72:75], v[68:71], 0
    s_waitcnt lgkmcnt(4)
    v_mfma_f32_16x16x32_bf16 v[24:27], v[76:79], v[56:59], v[24:27]
    v_mfma_f32_16x16x32_bf16 v[28:31], v[76:79], v[60:63], v[28:31]
    ds_read_b64 v[88:89], v3 offset:2560
    ds_read_b64 v[90:91], v3 offset:2568
    v_mfma_f32_16x16x32_bf16 v[32:35], v[76:79], v[64:67], v[32:35]
    v_mfma_f32_16x16x32_bf16 v[36:39], v[76:79], v[68:71], 0
    s_waitcnt lgkmcnt(4)
    v_mfma_f32_16x16x32_bf16 v[28:31], v[80:83], v[56:59], v[28:31]
    ds_read_b64 v[92:93], v3 offset:3072
    ds_read_b64 v[94:95], v3 offset:3080
    v_mfma_f32_16x16x32_bf16 v[32:35], v[80:83], v[60:63], v[32:35]
    v_mfma_f32_16x16x32_bf16 v[36:39], v[80:83], v[64:67], v[36:39]
    ds_read_b64 v[96:97], v3 offset:3584
    ds_read_b64 v[98:99], v3 offset:3592
    v_mfma_f32_16x16x32_bf16 v[40:43], v[80:83], v[68:71], 0
    ds_read_b64 v[100:101], v3 offset:64
    ds_read_b64 v[102:103], v3 offset:72
    s_waitcnt lgkmcnt(8)
    v_mfma_f32_16x16x32_bf16 v[32:35], v[84:87], v[56:59], v[32:35]
    ds_read_b128 v[104:107], v4 offset:3648
    ds_read_b128 v[108:111], v4 offset:3136
    v_mfma_f32_16x16x32_bf16 v[36:39], v[84:87], v[60:63], v[36:39]
    ds_read_b128 v[112:115], v4 offset:2624
    v_mfma_f32_16x16x32_bf16 v[40:43], v[84:87], v[64:67], v[40:43]
    ds_read_b128 v[116:119], v4 offset:2112
    v_mfma_f32_16x16x32_bf16 v[44:47], v[84:87], v[68:71], 0
    ds_read_b64 v[120:121], v3 offset:576
    ds_read_b64 v[122:123], v3 offset:584
    s_waitcnt lgkmcnt(8)
    v_mfma_f32_16x16x32_bf16 v[36:39], v[88:91], v[56:59], v[36:39]
    v_mfma_f32_16x16x32_bf16 v[40:43], v[88:91], v[60:63], v[40:43]
    v_mfma_f32_16x16x32_bf16 v[44:47], v[88:91], v[64:67], v[44:47]
    v_mfma_f32_16x16x32_bf16 v[40:43], v[92:95], v[56:59], v[40:43]
    ds_read_b64 v[124:125], v3 offset:1088
    ds_read_b64 v[126:127], v3 offset:1096
    v_mfma_f32_16x16x32_bf16 v[44:47], v[92:95], v[60:63], v[44:47]
    v_mfma_f32_16x16x32_bf16 v[44:47], v[96:99], v[56:59], v[44:47]
    s_waitcnt lgkmcnt(7)
    v_mfma_f32_16x16x32_bf16 v[16:19], v[100:103], v[104:107], v[16:19]
    s_waitcnt lgkmcnt(6)
    v_mfma_f32_16x16x32_bf16 v[20:23], v[100:103], v[108:111], v[20:23]
    ds_read_b64 v[128:129], v3 offset:1600
    ds_read_b64 v[130:131], v3 offset:1608
    s_waitcnt lgkmcnt(7)
    v_mfma_f32_16x16x32_bf16 v[24:27], v[100:103], v[112:115], v[24:27]
    s_waitcnt lgkmcnt(6)
    v_mfma_f32_16x16x32_bf16 v[28:31], v[100:103], v[116:119], v[28:31]
    s_waitcnt lgkmcnt(4)
    v_mfma_f32_16x16x32_bf16 v[20:23], v[120:123], v[104:107], v[20:23]
    v_mfma_f32_16x16x32_bf16 v[24:27], v[120:123], v[108:111], v[24:27]
    ds_read_b64 v[132:133], v3 offset:2112
    ds_read_b64 v[134:135], v3 offset:2120
    v_mfma_f32_16x16x32_bf16 v[28:31], v[120:123], v[112:115], v[28:31]
    v_mfma_f32_16x16x32_bf16 v[32:35], v[120:123], v[116:119], v[32:35]
    s_waitcnt lgkmcnt(4)
    v_mfma_f32_16x16x32_bf16 v[24:27], v[124:127], v[104:107], v[24:27]
    v_mfma_f32_16x16x32_bf16 v[28:31], v[124:127], v[108:111], v[28:31]
    ds_read_b64 v[136:137], v3 offset:2624
    ds_read_b64 v[138:139], v3 offset:2632
    v_mfma_f32_16x16x32_bf16 v[32:35], v[124:127], v[112:115], v[32:35]
    v_mfma_f32_16x16x32_bf16 v[36:39], v[124:127], v[116:119], v[36:39]
    s_waitcnt lgkmcnt(4)
    v_mfma_f32_16x16x32_bf16 v[28:31], v[128:131], v[104:107], v[28:31]
    ds_read_b64 v[140:141], v3 offset:3136
    ds_read_b64 v[142:143], v3 offset:3144
    v_mfma_f32_16x16x32_bf16 v[32:35], v[128:131], v[108:111], v[32:35]
    v_mfma_f32_16x16x32_bf16 v[36:39], v[128:131], v[112:115], v[36:39]
    ds_read_b64 v[144:145], v3 offset:3648
    ds_read_b64 v[146:147], v3 offset:3656
    v_mfma_f32_16x16x32_bf16 v[40:43], v[128:131], v[116:119], v[40:43]
    ds_read_b64 v[148:149], v3 offset:128
    ds_read_b64 v[150:151], v3 offset:136
    s_waitcnt lgkmcnt(8)
    v_mfma_f32_16x16x32_bf16 v[32:35], v[132:135], v[104:107], v[32:35]
    ds_read_b128 v[152:155], v4 offset:3712
    ds_read_b128 v[156:159], v4 offset:3200
    v_mfma_f32_16x16x32_bf16 v[36:39], v[132:135], v[108:111], v[36:39]
    ds_read_b128 v[160:163], v4 offset:2688
    v_mfma_f32_16x16x32_bf16 v[40:43], v[132:135], v[112:115], v[40:43]
    ds_read_b128 v[164:167], v4 offset:2176
    v_mfma_f32_16x16x32_bf16 v[44:47], v[132:135], v[116:119], v[44:47]
    ds_read_b64 v[52:53], v3 offset:640
    ds_read_b64 v[54:55], v3 offset:648
    s_waitcnt lgkmcnt(8)
    v_mfma_f32_16x16x32_bf16 v[36:39], v[136:139], v[104:107], v[36:39]
    v_mfma_f32_16x16x32_bf16 v[40:43], v[136:139], v[108:111], v[40:43]
    v_mfma_f32_16x16x32_bf16 v[44:47], v[136:139], v[112:115], v[44:47]
    v_mfma_f32_16x16x32_bf16 v[40:43], v[140:143], v[104:107], v[40:43]
    ds_read_b64 v[72:73], v3 offset:1152
    ds_read_b64 v[74:75], v3 offset:1160
    v_mfma_f32_16x16x32_bf16 v[44:47], v[140:143], v[108:111], v[44:47]
    v_mfma_f32_16x16x32_bf16 v[44:47], v[144:147], v[104:107], v[44:47]
    s_waitcnt lgkmcnt(7)
    v_mfma_f32_16x16x32_bf16 v[16:19], v[148:151], v[152:155], v[16:19]
    s_waitcnt lgkmcnt(6)
    v_mfma_f32_16x16x32_bf16 v[20:23], v[148:151], v[156:159], v[20:23]
    ds_read_b64 v[76:77], v3 offset:1664
    ds_read_b64 v[78:79], v3 offset:1672
    s_waitcnt lgkmcnt(7)
    v_mfma_f32_16x16x32_bf16 v[24:27], v[148:151], v[160:163], v[24:27]
    s_waitcnt lgkmcnt(6)
    v_mfma_f32_16x16x32_bf16 v[28:31], v[148:151], v[164:167], v[28:31]
    s_waitcnt lgkmcnt(4)
    v_mfma_f32_16x16x32_bf16 v[20:23], v[52:55], v[152:155], v[20:23]
    v_mfma_f32_16x16x32_bf16 v[24:27], v[52:55], v[156:159], v[24:27]
    ds_read_b64 v[80:81], v3 offset:2176
    ds_read_b64 v[82:83], v3 offset:2184
    v_mfma_f32_16x16x32_bf16 v[28:31], v[52:55], v[160:163], v[28:31]
    v_mfma_f32_16x16x32_bf16 v[32:35], v[52:55], v[164:167], v[32:35]
    s_waitcnt lgkmcnt(4)
    v_mfma_f32_16x16x32_bf16 v[24:27], v[72:75], v[152:155], v[24:27]
    v_mfma_f32_16x16x32_bf16 v[28:31], v[72:75], v[156:159], v[28:31]
    ds_read_b64 v[84:85], v3 offset:2688
    ds_read_b64 v[86:87], v3 offset:2696
    v_mfma_f32_16x16x32_bf16 v[32:35], v[72:75], v[160:163], v[32:35]
    v_mfma_f32_16x16x32_bf16 v[36:39], v[72:75], v[164:167], v[36:39]
    s_waitcnt lgkmcnt(4)
    v_mfma_f32_16x16x32_bf16 v[28:31], v[76:79], v[152:155], v[28:31]
    ds_read_b64 v[68:69], v3 offset:3200
    ds_read_b64 v[70:71], v3 offset:3208
    v_mfma_f32_16x16x32_bf16 v[32:35], v[76:79], v[156:159], v[32:35]
    v_mfma_f32_16x16x32_bf16 v[36:39], v[76:79], v[160:163], v[36:39]
    ds_read_b64 v[88:89], v3 offset:3712
    ds_read_b64 v[90:91], v3 offset:3720
    v_mfma_f32_16x16x32_bf16 v[40:43], v[76:79], v[164:167], v[40:43]
    ds_read_b64 v[64:65], v3 offset:192
    ds_read_b64 v[66:67], v3 offset:200
    s_waitcnt lgkmcnt(8)
    v_mfma_f32_16x16x32_bf16 v[32:35], v[80:83], v[152:155], v[32:35]
    ds_read_b128 v[92:95], v4 offset:3776
    ds_read_b128 v[60:63], v4 offset:3264
    v_mfma_f32_16x16x32_bf16 v[36:39], v[80:83], v[156:159], v[36:39]
    ds_read_b128 v[96:99], v4 offset:2752
    v_mfma_f32_16x16x32_bf16 v[40:43], v[80:83], v[160:163], v[40:43]
    ds_read_b128 v[56:59], v4 offset:2240
    v_mfma_f32_16x16x32_bf16 v[44:47], v[80:83], v[164:167], v[44:47]
    ds_read_b64 v[100:101], v3 offset:704
    ds_read_b64 v[102:103], v3 offset:712
    s_waitcnt lgkmcnt(8)
    v_mfma_f32_16x16x32_bf16 v[36:39], v[84:87], v[152:155], v[36:39]
    v_mfma_f32_16x16x32_bf16 v[40:43], v[84:87], v[156:159], v[40:43]
    v_mfma_f32_16x16x32_bf16 v[44:47], v[84:87], v[160:163], v[44:47]
    v_mfma_f32_16x16x32_bf16 v[40:43], v[68:71], v[152:155], v[40:43]
    ds_read_b64 v[120:121], v3 offset:1216
    ds_read_b64 v[122:123], v3 offset:1224
    v_mfma_f32_16x16x32_bf16 v[44:47], v[68:71], v[156:159], v[44:47]
    v_mfma_f32_16x16x32_bf16 v[44:47], v[88:91], v[152:155], v[44:47]
    s_waitcnt lgkmcnt(7)
    v_mfma_f32_16x16x32_bf16 v[16:19], v[64:67], v[92:95], v[16:19]
    s_waitcnt lgkmcnt(6)
    v_mfma_f32_16x16x32_bf16 v[20:23], v[64:67], v[60:63], v[20:23]
    ds_read_b64 v[124:125], v3 offset:1728
    ds_read_b64 v[126:127], v3 offset:1736
    s_waitcnt lgkmcnt(7)
    v_mfma_f32_16x16x32_bf16 v[24:27], v[64:67], v[96:99], v[24:27]
    s_waitcnt lgkmcnt(6)
    v_mfma_f32_16x16x32_bf16 v[28:31], v[64:67], v[56:59], v[28:31]
    s_waitcnt lgkmcnt(4)
    v_mfma_f32_16x16x32_bf16 v[20:23], v[100:103], v[92:95], v[20:23]
    v_mfma_f32_16x16x32_bf16 v[24:27], v[100:103], v[60:63], v[24:27]
    ds_read_b64 v[128:129], v3 offset:2240
    ds_read_b64 v[130:131], v3 offset:2248
    v_mfma_f32_16x16x32_bf16 v[28:31], v[100:103], v[96:99], v[28:31]
    v_mfma_f32_16x16x32_bf16 v[32:35], v[100:103], v[56:59], v[32:35]
    s_waitcnt lgkmcnt(4)
    v_mfma_f32_16x16x32_bf16 v[24:27], v[120:123], v[92:95], v[24:27]
    v_mfma_f32_16x16x32_bf16 v[28:31], v[120:123], v[60:63], v[28:31]
    ds_read_b64 v[132:133], v3 offset:2752
    ds_read_b64 v[134:135], v3 offset:2760
    v_mfma_f32_16x16x32_bf16 v[32:35], v[120:123], v[96:99], v[32:35]
    v_mfma_f32_16x16x32_bf16 v[36:39], v[120:123], v[56:59], v[36:39]
    s_waitcnt lgkmcnt(4)
    v_mfma_f32_16x16x32_bf16 v[28:31], v[124:127], v[92:95], v[28:31]
    ds_read_b64 v[116:117], v3 offset:3264
    ds_read_b64 v[118:119], v3 offset:3272
    v_mfma_f32_16x16x32_bf16 v[32:35], v[124:127], v[60:63], v[32:35]
    v_mfma_f32_16x16x32_bf16 v[36:39], v[124:127], v[96:99], v[36:39]
    ds_read_b64 v[136:137], v3 offset:3776
    ds_read_b64 v[138:139], v3 offset:3784
    v_mfma_f32_16x16x32_bf16 v[40:43], v[124:127], v[56:59], v[40:43]
    ds_read_b64 v[112:113], v3 offset:256
    ds_read_b64 v[114:115], v3 offset:264
    s_waitcnt lgkmcnt(8)
    v_mfma_f32_16x16x32_bf16 v[32:35], v[128:131], v[92:95], v[32:35]
    ds_read_b128 v[140:143], v4 offset:3840
    ds_read_b128 v[108:111], v4 offset:3328
    v_mfma_f32_16x16x32_bf16 v[36:39], v[128:131], v[60:63], v[36:39]
    ds_read_b128 v[144:147], v4 offset:2816
    v_mfma_f32_16x16x32_bf16 v[40:43], v[128:131], v[96:99], v[40:43]
    ds_read_b128 v[104:107], v4 offset:2304
    v_mfma_f32_16x16x32_bf16 v[44:47], v[128:131], v[56:59], v[44:47]
    ds_read_b64 v[148:149], v3 offset:768
    ds_read_b64 v[150:151], v3 offset:776
    s_waitcnt lgkmcnt(8)
    v_mfma_f32_16x16x32_bf16 v[36:39], v[132:135], v[92:95], v[36:39]
    v_mfma_f32_16x16x32_bf16 v[40:43], v[132:135], v[60:63], v[40:43]
    v_mfma_f32_16x16x32_bf16 v[44:47], v[132:135], v[96:99], v[44:47]
    v_mfma_f32_16x16x32_bf16 v[40:43], v[116:119], v[92:95], v[40:43]
    ds_read_b64 v[52:53], v3 offset:1280
    ds_read_b64 v[54:55], v3 offset:1288
    v_mfma_f32_16x16x32_bf16 v[44:47], v[116:119], v[60:63], v[44:47]
    v_mfma_f32_16x16x32_bf16 v[44:47], v[136:139], v[92:95], v[44:47]
    s_waitcnt lgkmcnt(7)
    v_mfma_f32_16x16x32_bf16 v[16:19], v[112:115], v[140:143], v[16:19]
    s_waitcnt lgkmcnt(6)
    v_mfma_f32_16x16x32_bf16 v[20:23], v[112:115], v[108:111], v[20:23]
    ds_read_b64 v[72:73], v3 offset:1792
    ds_read_b64 v[74:75], v3 offset:1800
    s_waitcnt lgkmcnt(7)
    v_mfma_f32_16x16x32_bf16 v[24:27], v[112:115], v[144:147], v[24:27]
    s_waitcnt lgkmcnt(6)
    v_mfma_f32_16x16x32_bf16 v[28:31], v[112:115], v[104:107], v[28:31]
    s_waitcnt lgkmcnt(4)
    v_mfma_f32_16x16x32_bf16 v[20:23], v[148:151], v[140:143], v[20:23]
    v_mfma_f32_16x16x32_bf16 v[24:27], v[148:151], v[108:111], v[24:27]
    ds_read_b64 v[76:77], v3 offset:2304
    ds_read_b64 v[78:79], v3 offset:2312
    v_mfma_f32_16x16x32_bf16 v[28:31], v[148:151], v[144:147], v[28:31]
    v_mfma_f32_16x16x32_bf16 v[32:35], v[148:151], v[104:107], v[32:35]
    s_waitcnt lgkmcnt(4)
    v_mfma_f32_16x16x32_bf16 v[24:27], v[52:55], v[140:143], v[24:27]
    v_mfma_f32_16x16x32_bf16 v[28:31], v[52:55], v[108:111], v[28:31]
    ds_read_b64 v[80:81], v3 offset:2816
    ds_read_b64 v[82:83], v3 offset:2824
    v_mfma_f32_16x16x32_bf16 v[32:35], v[52:55], v[144:147], v[32:35]
    v_mfma_f32_16x16x32_bf16 v[36:39], v[52:55], v[104:107], v[36:39]
    s_waitcnt lgkmcnt(4)
    v_mfma_f32_16x16x32_bf16 v[28:31], v[72:75], v[140:143], v[28:31]
    ds_read_b64 v[164:165], v3 offset:3328
    ds_read_b64 v[166:167], v3 offset:3336
    v_mfma_f32_16x16x32_bf16 v[32:35], v[72:75], v[108:111], v[32:35]
    v_mfma_f32_16x16x32_bf16 v[36:39], v[72:75], v[144:147], v[36:39]
    ds_read_b64 v[84:85], v3 offset:3840
    ds_read_b64 v[86:87], v3 offset:3848
    v_mfma_f32_16x16x32_bf16 v[40:43], v[72:75], v[104:107], v[40:43]
    ds_read_b64 v[160:161], v3 offset:320
    ds_read_b64 v[162:163], v3 offset:328
    s_waitcnt lgkmcnt(8)
    v_mfma_f32_16x16x32_bf16 v[32:35], v[76:79], v[140:143], v[32:35]
    ds_read_b128 v[68:71], v4 offset:3904
    ds_read_b128 v[156:159], v4 offset:3392
    v_mfma_f32_16x16x32_bf16 v[36:39], v[76:79], v[108:111], v[36:39]
    ds_read_b128 v[88:91], v4 offset:2880
    v_mfma_f32_16x16x32_bf16 v[40:43], v[76:79], v[144:147], v[40:43]
    ds_read_b128 v[152:155], v4 offset:2368
    v_mfma_f32_16x16x32_bf16 v[44:47], v[76:79], v[104:107], v[44:47]
    ds_read_b64 v[64:65], v3 offset:832
    ds_read_b64 v[66:67], v3 offset:840
    s_waitcnt lgkmcnt(8)
    v_mfma_f32_16x16x32_bf16 v[36:39], v[80:83], v[140:143], v[36:39]
    v_mfma_f32_16x16x32_bf16 v[40:43], v[80:83], v[108:111], v[40:43]
    v_mfma_f32_16x16x32_bf16 v[44:47], v[80:83], v[144:147], v[44:47]
    v_mfma_f32_16x16x32_bf16 v[40:43], v[164:167], v[140:143], v[40:43]
    ds_read_b64 v[100:101], v3 offset:1344
    ds_read_b64 v[102:103], v3 offset:1352
    v_mfma_f32_16x16x32_bf16 v[44:47], v[164:167], v[108:111], v[44:47]
    v_mfma_f32_16x16x32_bf16 v[44:47], v[84:87], v[140:143], v[44:47]
    s_waitcnt lgkmcnt(7)
    v_mfma_f32_16x16x32_bf16 v[16:19], v[160:163], v[68:71], v[16:19]
    s_waitcnt lgkmcnt(6)
    v_mfma_f32_16x16x32_bf16 v[20:23], v[160:163], v[156:159], v[20:23]
    ds_read_b64 v[120:121], v3 offset:1856
    ds_read_b64 v[122:123], v3 offset:1864
    s_waitcnt lgkmcnt(7)
    v_mfma_f32_16x16x32_bf16 v[24:27], v[160:163], v[88:91], v[24:27]
    s_waitcnt lgkmcnt(6)
    v_mfma_f32_16x16x32_bf16 v[28:31], v[160:163], v[152:155], v[28:31]
    s_waitcnt lgkmcnt(4)
    v_mfma_f32_16x16x32_bf16 v[20:23], v[64:67], v[68:71], v[20:23]
    v_mfma_f32_16x16x32_bf16 v[24:27], v[64:67], v[156:159], v[24:27]
    ds_read_b64 v[124:125], v3 offset:2368
    ds_read_b64 v[126:127], v3 offset:2376
    v_mfma_f32_16x16x32_bf16 v[28:31], v[64:67], v[88:91], v[28:31]
    v_mfma_f32_16x16x32_bf16 v[32:35], v[64:67], v[152:155], v[32:35]
    s_waitcnt lgkmcnt(4)
    v_mfma_f32_16x16x32_bf16 v[24:27], v[100:103], v[68:71], v[24:27]
    v_mfma_f32_16x16x32_bf16 v[28:31], v[100:103], v[156:159], v[28:31]
    ds_read_b64 v[128:129], v3 offset:2880
    ds_read_b64 v[130:131], v3 offset:2888
    v_mfma_f32_16x16x32_bf16 v[32:35], v[100:103], v[88:91], v[32:35]
    v_mfma_f32_16x16x32_bf16 v[36:39], v[100:103], v[152:155], v[36:39]
    s_waitcnt lgkmcnt(4)
    v_mfma_f32_16x16x32_bf16 v[28:31], v[120:123], v[68:71], v[28:31]
    ds_read_b64 v[56:57], v3 offset:3392
    ds_read_b64 v[58:59], v3 offset:3400
    v_mfma_f32_16x16x32_bf16 v[32:35], v[120:123], v[156:159], v[32:35]
    v_mfma_f32_16x16x32_bf16 v[36:39], v[120:123], v[88:91], v[36:39]
    ds_read_b64 v[132:133], v3 offset:3904
    ds_read_b64 v[134:135], v3 offset:3912
    v_mfma_f32_16x16x32_bf16 v[40:43], v[120:123], v[152:155], v[40:43]
    ds_read_b64 v[96:97], v3 offset:384
    ds_read_b64 v[98:99], v3 offset:392
    s_waitcnt lgkmcnt(8)
    v_mfma_f32_16x16x32_bf16 v[32:35], v[124:127], v[68:71], v[32:35]
    ds_read_b128 v[116:119], v4 offset:3968
    ds_read_b128 v[60:63], v4 offset:3456
    v_mfma_f32_16x16x32_bf16 v[36:39], v[124:127], v[156:159], v[36:39]
    ds_read_b128 v[136:139], v4 offset:2944
    v_mfma_f32_16x16x32_bf16 v[40:43], v[124:127], v[88:91], v[40:43]
    ds_read_b128 v[92:95], v4 offset:2432
    v_mfma_f32_16x16x32_bf16 v[44:47], v[124:127], v[152:155], v[44:47]
    ds_read_b64 v[112:113], v3 offset:896
    ds_read_b64 v[114:115], v3 offset:904
    s_waitcnt lgkmcnt(8)
    v_mfma_f32_16x16x32_bf16 v[36:39], v[128:131], v[68:71], v[36:39]
    v_mfma_f32_16x16x32_bf16 v[40:43], v[128:131], v[156:159], v[40:43]
    v_mfma_f32_16x16x32_bf16 v[44:47], v[128:131], v[88:91], v[44:47]
    v_mfma_f32_16x16x32_bf16 v[40:43], v[56:59], v[68:71], v[40:43]
    ds_read_b64 v[148:149], v3 offset:1408
    ds_read_b64 v[150:151], v3 offset:1416
    v_mfma_f32_16x16x32_bf16 v[44:47], v[56:59], v[156:159], v[44:47]
    v_mfma_f32_16x16x32_bf16 v[44:47], v[132:135], v[68:71], v[44:47]
    s_waitcnt lgkmcnt(7)
    v_mfma_f32_16x16x32_bf16 v[16:19], v[96:99], v[116:119], v[16:19]
    s_waitcnt lgkmcnt(6)
    v_mfma_f32_16x16x32_bf16 v[20:23], v[96:99], v[60:63], v[20:23]
    ds_read_b64 v[52:53], v3 offset:1920
    ds_read_b64 v[54:55], v3 offset:1928
    s_waitcnt lgkmcnt(7)
    v_mfma_f32_16x16x32_bf16 v[24:27], v[96:99], v[136:139], v[24:27]
    s_waitcnt lgkmcnt(6)
    v_mfma_f32_16x16x32_bf16 v[28:31], v[96:99], v[92:95], v[28:31]
    s_waitcnt lgkmcnt(4)
    v_mfma_f32_16x16x32_bf16 v[20:23], v[112:115], v[116:119], v[20:23]
    v_mfma_f32_16x16x32_bf16 v[24:27], v[112:115], v[60:63], v[24:27]
    ds_read_b64 v[72:73], v3 offset:2432
    ds_read_b64 v[74:75], v3 offset:2440
    v_mfma_f32_16x16x32_bf16 v[28:31], v[112:115], v[136:139], v[28:31]
    v_mfma_f32_16x16x32_bf16 v[32:35], v[112:115], v[92:95], v[32:35]
    s_waitcnt lgkmcnt(4)
    v_mfma_f32_16x16x32_bf16 v[24:27], v[148:151], v[116:119], v[24:27]
    v_mfma_f32_16x16x32_bf16 v[28:31], v[148:151], v[60:63], v[28:31]
    ds_read_b64 v[76:77], v3 offset:2944
    ds_read_b64 v[78:79], v3 offset:2952
    v_mfma_f32_16x16x32_bf16 v[32:35], v[148:151], v[136:139], v[32:35]
    v_mfma_f32_16x16x32_bf16 v[36:39], v[148:151], v[92:95], v[36:39]
    s_waitcnt lgkmcnt(4)
    v_mfma_f32_16x16x32_bf16 v[28:31], v[52:55], v[116:119], v[28:31]
    ds_read_b64 v[104:105], v3 offset:3456
    ds_read_b64 v[106:107], v3 offset:3464
    v_mfma_f32_16x16x32_bf16 v[32:35], v[52:55], v[60:63], v[32:35]
    v_mfma_f32_16x16x32_bf16 v[36:39], v[52:55], v[136:139], v[36:39]
    ds_read_b64 v[80:81], v3 offset:3968
    ds_read_b64 v[82:83], v3 offset:3976
    v_mfma_f32_16x16x32_bf16 v[40:43], v[52:55], v[92:95], v[40:43]
    ds_read_b64 v[144:145], v3 offset:448
    ds_read_b64 v[146:147], v3 offset:456
    s_waitcnt lgkmcnt(8)
    v_mfma_f32_16x16x32_bf16 v[32:35], v[72:75], v[116:119], v[32:35]
    ds_read_b128 v[164:167], v4 offset:4032
    ds_read_b128 v[108:111], v4 offset:3520
    v_mfma_f32_16x16x32_bf16 v[36:39], v[72:75], v[60:63], v[36:39]
    ds_read_b128 v[84:87], v4 offset:3008
    v_mfma_f32_16x16x32_bf16 v[40:43], v[72:75], v[136:139], v[40:43]
    ds_read_b128 v[140:143], v4 offset:2496
    v_mfma_f32_16x16x32_bf16 v[44:47], v[72:75], v[92:95], v[44:47]
    ds_read_b64 v[160:161], v3 offset:960
    ds_read_b64 v[162:163], v3 offset:968
    s_waitcnt lgkmcnt(8)
    v_mfma_f32_16x16x32_bf16 v[36:39], v[76:79], v[116:119], v[36:39]
    v_mfma_f32_16x16x32_bf16 v[40:43], v[76:79], v[60:63], v[40:43]
    v_mfma_f32_16x16x32_bf16 v[44:47], v[76:79], v[136:139], v[44:47]
    v_mfma_f32_16x16x32_bf16 v[40:43], v[104:107], v[116:119], v[40:43]
    ds_read_b64 v[64:65], v3 offset:1472
    ds_read_b64 v[66:67], v3 offset:1480
    v_mfma_f32_16x16x32_bf16 v[44:47], v[104:107], v[60:63], v[44:47]
    v_mfma_f32_16x16x32_bf16 v[44:47], v[80:83], v[116:119], v[44:47]
    s_waitcnt lgkmcnt(7)
    v_mfma_f32_16x16x32_bf16 v[16:19], v[144:147], v[164:167], v[16:19]
    s_waitcnt lgkmcnt(6)
    v_mfma_f32_16x16x32_bf16 v[20:23], v[144:147], v[108:111], v[20:23]
    ds_read_b64 v[100:101], v3 offset:1984
    ds_read_b64 v[102:103], v3 offset:1992
    s_waitcnt lgkmcnt(7)
    v_mfma_f32_16x16x32_bf16 v[24:27], v[144:147], v[84:87], v[24:27]
    s_waitcnt lgkmcnt(6)
    v_mfma_f32_16x16x32_bf16 v[28:31], v[144:147], v[140:143], v[28:31]
    s_waitcnt lgkmcnt(4)
    v_mfma_f32_16x16x32_bf16 v[20:23], v[160:163], v[164:167], v[20:23]
    v_mfma_f32_16x16x32_bf16 v[24:27], v[160:163], v[108:111], v[24:27]
    ds_read_b64 v[120:121], v3 offset:2496
    ds_read_b64 v[122:123], v3 offset:2504
    v_mfma_f32_16x16x32_bf16 v[28:31], v[160:163], v[84:87], v[28:31]
    v_mfma_f32_16x16x32_bf16 v[32:35], v[160:163], v[140:143], v[32:35]
    s_waitcnt lgkmcnt(4)
    v_mfma_f32_16x16x32_bf16 v[24:27], v[64:67], v[164:167], v[24:27]
    v_mfma_f32_16x16x32_bf16 v[28:31], v[64:67], v[108:111], v[28:31]
    ds_read_b64 v[124:125], v3 offset:3008
    ds_read_b64 v[126:127], v3 offset:3016
    v_mfma_f32_16x16x32_bf16 v[32:35], v[64:67], v[84:87], v[32:35]
    v_mfma_f32_16x16x32_bf16 v[36:39], v[64:67], v[140:143], v[36:39]
    s_waitcnt lgkmcnt(4)
    v_mfma_f32_16x16x32_bf16 v[28:31], v[100:103], v[164:167], v[28:31]
    ds_read_b64 v[152:153], v3 offset:3520
    ds_read_b64 v[154:155], v3 offset:3528
    v_mfma_f32_16x16x32_bf16 v[32:35], v[100:103], v[108:111], v[32:35]
    v_mfma_f32_16x16x32_bf16 v[36:39], v[100:103], v[84:87], v[36:39]
    ds_read_b64 v[128:129], v3 offset:4032
    ds_read_b64 v[130:131], v3 offset:4040
    v_mfma_f32_16x16x32_bf16 v[40:43], v[100:103], v[140:143], v[40:43]
    ds_read_b64 v[88:89], v3 offset:0
    ds_read_b64 v[90:91], v3 offset:8
    s_waitcnt lgkmcnt(8)
    v_mfma_f32_16x16x32_bf16 v[32:35], v[120:123], v[164:167], v[32:35]
    s_mov_b32 s59, 0
    s_branch WI20
WL20:
    s_sleep 1
WI20:
    ds_read_b32 v14, v15 offset:16
    s_add_u32 s59, s59, 1
    s_waitcnt lgkmcnt(0)
    v_cmp_gt_u32 vcc, 4, v14
    s_cmp_ge_u32 s59, 524288
    s_cbranch_scc1 WX20
    s_nop 2
    s_cbranch_vccnz WL20
WX20:
    ds_read_b128 v[56:59], v4 offset:1536
    ds_read_b128 v[156:159], v4 offset:1024
    v_mfma_f32_16x16x32_bf16 v[36:39], v[120:123], v[108:111], v[36:39]
    ds_read_b128 v[132:135], v4 offset:512
    v_mfma_f32_16x16x32_bf16 v[40:43], v[120:123], v[84:87], v[40:43]
    ds_read_b128 v[68:71], v4 offset:0
    v_mfma_f32_16x16x32_bf16 v[44:47], v[120:123], v[140:143], v[44:47]
    ds_read_b64 v[96:97], v3 offset:512
    ds_read_b64 v[98:99], v3 offset:520
    v_mfma_f32_16x16x32_bf16 v[36:39], v[124:127], v[164:167], v[36:39]
    v_mfma_f32_16x16x32_bf16 v[40:43], v[124:127], v[108:111], v[40:43]
    v_mfma_f32_16x16x32_bf16 v[44:47], v[124:127], v[84:87], v[44:47]
    ds_read_b64 v[112:113], v3 offset:1024
    ds_read_b64 v[114:115], v3 offset:1032
    v_mfma_f32_16x16x32_bf16 v[40:43], v[152:155], v[164:167], v[40:43]
    v_mfma_f32_16x16x32_bf16 v[44:47], v[152:155], v[108:111], v[44:47]
    ds_read_b64 v[148:149], v3 offset:1536
    ds_read_b64 v[150:151], v3 offset:1544
    v_mfma_f32_16x16x32_bf16 v[44:47], v[128:131], v[164:167], v[44:47]
    ds_read_b64 v[52:53], v3 offset:64
    ds_read_b64 v[54:55], v3 offset:72
    s_waitcnt lgkmcnt(7)
    v_mfma_f32_16x16x32_bf16 v[32:35], v[88:91], v[56:59], v[32:35]
    ds_read_b128 v[72:75], v4 offset:1600
    ds_read_b128 v[92:95], v4 offset:1088
    v_mfma_f32_16x16x32_bf16 v[36:39], v[88:91], v[156:159], v[36:39]
    ds_read_b128 v[76:79], v4 offset:576
    v_mfma_f32_16x16x32_bf16 v[40:43], v[88:91], v[132:135], v[40:43]
    ds_read_b128 v[136:139], v4 offset:64
    v_mfma_f32_16x16x32_bf16 v[44:47], v[88:91], v[68:71], v[44:47]
    ds_read_b64 v[104:105], v3 offset:576
    ds_read_b64 v[106:107], v3 offset:584
    s_waitcnt lgkmcnt(8)
    v_mfma_f32_16x16x32_bf16 v[36:39], v[96:99], v[56:59], v[36:39]
    v_cvt_pk_bf16_f32 v48, v16, v17
    v_cvt_pk_bf16_f32 v49, v18, v19
    ds_write_b64 v12, v[48:49] offset:7880
    v_cvt_pk_bf16_f32 v50, v20, v21
    v_cvt_pk_bf16_f32 v51, v22, v23
    ds_write_b64 v12, v[50:51] offset:7368
    v_cvt_pk_bf16_f32 v48, v24, v25
    v_cvt_pk_bf16_f32 v49, v26, v27
    ds_write_b64 v12, v[48:49] offset:6856
    v_cvt_pk_bf16_f32 v50, v28, v29
    v_cvt_pk_bf16_f32 v51, v30, v31
    ds_write_b64 v12, v[50:51] offset:6344
    s_setprio 0
    s_mov_b64 exec, 1
    ds_add_u32 v15, v11 offset:32
    s_mov_b64 exec, -1
    v_mfma_f32_16x16x32_bf16 v[40:43], v[96:99], v[156:159], v[40:43]
    v_mfma_f32_16x16x32_bf16 v[44:47], v[96:99], v[132:135], v[44:47]
    ds_read_b64 v[60:61], v3 offset:1088
    ds_read_b64 v[62:63], v3 offset:1096
    v_mfma_f32_16x16x32_bf16 v[40:43], v[112:115], v[56:59], v[40:43]
    v_mfma_f32_16x16x32_bf16 v[44:47], v[112:115], v[156:159], v[44:47]
    ds_read_b64 v[80:81], v3 offset:1600
    ds_read_b64 v[82:83], v3 offset:1608
    v_mfma_f32_16x16x32_bf16 v[44:47], v[148:151], v[56:59], v[44:47]
    ds_read_b64 v[116:117], v3 offset:128
    ds_read_b64 v[118:119], v3 offset:136
    s_waitcnt lgkmcnt(11)
    v_mfma_f32_16x16x32_bf16 v[32:35], v[52:55], v[72:75], v[32:35]
    ds_read_b128 v[144:147], v4 offset:1664
    ds_read_b128 v[160:163], v4 offset:1152
    v_mfma_f32_16x16x32_bf16 v[36:39], v[52:55], v[92:95], v[36:39]
    ds_read_b128 v[64:67], v4 offset:640
    v_mfma_f32_16x16x32_bf16 v[40:43], v[52:55], v[76:79], v[40:43]
    ds_read_b128 v[100:103], v4 offset:128
    v_mfma_f32_16x16x32_bf16 v[44:47], v[52:55], v[136:139], v[44:47]
    ds_read_b64 v[120:121], v3 offset:640
    ds_read_b64 v[122:123], v3 offset:648
    v_mfma_f32_16x16x32_bf16 v[36:39], v[104:107], v[72:75], v[36:39]
    v_mfma_f32_16x16x32_bf16 v[40:43], v[104:107], v[92:95], v[40:43]
    v_mfma_f32_16x16x32_bf16 v[44:47], v[104:107], v[76:79], v[44:47]
    ds_read_b64 v[140:141], v3 offset:1152
    ds_read_b64 v[142:143], v3 offset:1160
    s_waitcnt lgkmcnt(8)
    v_mfma_f32_16x16x32_bf16 v[40:43], v[60:63], v[72:75], v[40:43]
    v_mfma_f32_16x16x32_bf16 v[44:47], v[60:63], v[92:95], v[44:47]
    ds_read_b64 v[124:125], v3 offset:1664
    ds_read_b64 v[126:127], v3 offset:1672
    v_mfma_f32_16x16x32_bf16 v[44:47], v[80:83], v[72:75], v[44:47]
    ds_read_b64 v[84:85], v3 offset:192
    ds_read_b64 v[86:87], v3 offset:200
    s_waitcnt lgkmcnt(7)
    v_mfma_f32_16x16x32_bf16 v[32:35], v[116:119], v[144:147], v[32:35]
    ds_read_b128 v[152:155], v4 offset:1728
    ds_read_b128 v[108:111], v4 offset:1216
    v_mfma_f32_16x16x32_bf16 v[36:39], v[116:119], v[160:163], v[36:39]
    ds_read_b128 v[128:131], v4 offset:704
    v_mfma_f32_16x16x32_bf16 v[40:43], v[116:119], v[64:67], v[40:43]
    ds_read_b128 v[164:167], v4 offset:192
    v_mfma_f32_16x16x32_bf16 v[44:47], v[116:119], v[100:103], v[44:47]
    ds_read_b64 v[88:89], v3 offset:704
    ds_read_b64 v[90:91], v3 offset:712
    s_waitcnt lgkmcnt(8)
    v_mfma_f32_16x16x32_bf16 v[36:39], v[120:123], v[144:147], v[36:39]
    v_mfma_f32_16x16x32_bf16 v[40:43], v[120:123], v[160:163], v[40:43]
    v_mfma_f32_16x16x32_bf16 v[44:47], v[120:123], v[64:67], v[44:47]
    ds_read_b64 v[68:69], v3 offset:1216
    ds_read_b64 v[70:71], v3 offset:1224
    v_mfma_f32_16x16x32_bf16 v[40:43], v[140:143], v[144:147], v[40:43]
    v_mfma_f32_16x16x32_bf16 v[44:47], v[140:143], v[160:163], v[44:47]
    ds_read_b64 v[96:97], v3 offset:1728
    ds_read_b64 v[98:99], v3 offset:1736
    v_mfma_f32_16x16x32_bf16 v[44:47], v[124:127], v[144:147], v[44:47]
    ds_read_b64 v[132:133], v3 offset:256
    ds_read_b64 v[134:135], v3 offset:264
    s_waitcnt lgkmcnt(7)
    v_mfma_f32_16x16x32_bf16 v[32:35], v[84:87], v[152:155], v[32:35]
    ds_read_b128 v[112:115], v4 offset:1792
    ds_read_b128 v[156:159], v4 offset:1280
    v_mfma_f32_16x16x32_bf16 v[36:39], v[84:87], v[108:111], v[36:39]
    ds_read_b128 v[148:151], v4 offset:768
    v_mfma_f32_16x16x32_bf16 v[40:43], v[84:87], v[128:131], v[40:43]
    ds_read_b128 v[56:59], v4 offset:256
    v_mfma_f32_16x16x32_bf16 v[44:47], v[84:87], v[164:167], v[44:47]
    ds_read_b64 v[52:53], v3 offset:768
    ds_read_b64 v[54:55], v3 offset:776
    s_waitcnt lgkmcnt(8)
    v_mfma_f32_16x16x32_bf16 v[36:39], v[88:91], v[152:155], v[36:39]
    v_mfma_f32_16x16x32_bf16 v[40:43], v[88:91], v[108:111], v[40:43]
    v_mfma_f32_16x16x32_bf16 v[44:47], v[88:91], v[128:131], v[44:47]
    ds_read_b64 v[136:137], v3 offset:1280
    ds_read_b64 v[138:139], v3 offset:1288
    v_mfma_f32_16x16x32_bf16 v[40:43], v[68:71], v[152:155], v[40:43]
    v_mfma_f32_16x16x32_bf16 v[44:47], v[68:71], v[108:111], v[44:47]
    ds_read_b64 v[104:105], v3 offset:1792
    ds_read_b64 v[106:107], v3 offset:1800
    v_mfma_f32_16x16x32_bf16 v[44:47], v[96:99], v[152:155], v[44:47]
    ds_read_b64 v[76:77], v3 offset:320
    ds_read_b64 v[78:79], v3 offset:328
    s_waitcnt lgkmcnt(7)
    v_mfma_f32_16x16x32_bf16 v[32:35], v[132:135], v[112:115], v[32:35]
    ds_read_b128 v[60:63], v4 offset:1856
    ds_read_b128 v[92:95], v4 offset:1344
    v_mfma_f32_16x16x32_bf16 v[36:39], v[132:135], v[156:159], v[36:39]
    ds_read_b128 v[80:83], v4 offset:832
    v_mfma_f32_16x16x32_bf16 v[40:43], v[132:135], v[148:151], v[40:43]
    ds_read_b128 v[72:75], v4 offset:320
    v_mfma_f32_16x16x32_bf16 v[44:47], v[132:135], v[56:59], v[44:47]
    ds_read_b64 v[116:117], v3 offset:832
    ds_read_b64 v[118:119], v3 offset:840
    s_waitcnt lgkmcnt(8)
    v_mfma_f32_16x16x32_bf16 v[36:39], v[52:55], v[112:115], v[36:39]
    v_mfma_f32_16x16x32_bf16 v[40:43], v[52:55], v[156:159], v[40:43]
    v_mfma_f32_16x16x32_bf16 v[44:47], v[52:55], v[148:151], v[44:47]
    ds_read_b64 v[100:101], v3 offset:1344
    ds_read_b64 v[102:103], v3 offset:1352
    v_mfma_f32_16x16x32_bf16 v[40:43], v[136:139], v[112:115], v[40:43]
    v_mfma_f32_16x16x32_bf16 v[44:47], v[136:139], v[156:159], v[44:47]
    ds_read_b64 v[120:121], v3 offset:1856
    ds_read_b64 v[122:123], v3 offset:1864
    v_mfma_f32_16x16x32_bf16 v[44:47], v[104:107], v[112:115], v[44:47]
    ds_read_b64 v[64:65], v3 offset:384
    ds_read_b64 v[66:67], v3 offset:392
    s_waitcnt lgkmcnt(7)
    v_mfma_f32_16x16x32_bf16 v[32:35], v[76:79], v[60:63], v[32:35]
    ds_read_b128 v[140:143], v4 offset:1920
    ds_read_b128 v[160:163], v4 offset:1408
    v_mfma_f32_16x16x32_bf16 v[36:39], v[76:79], v[92:95], v[36:39]
    ds_read_b128 v[124:127], v4 offset:896
    v_mfma_f32_16x16x32_bf16 v[40:43], v[76:79], v[80:83], v[40:43]
    ds_read_b128 v[144:147], v4 offset:384
    v_mfma_f32_16x16x32_bf16 v[44:47], v[76:79], v[72:75], v[44:47]
    ds_read_b64 v[84:85], v3 offset:896
    ds_read_b64 v[86:87], v3 offset:904
    s_waitcnt lgkmcnt(8)
    v_mfma_f32_16x16x32_bf16 v[36:39], v[116:119], v[60:63], v[36:39]
    v_mfma_f32_16x16x32_bf16 v[40:43], v[116:119], v[92:95], v[40:43]
    v_mfma_f32_16x16x32_bf16 v[44:47], v[116:119], v[80:83], v[44:47]
    ds_read_b64 v[164:165], v3 offset:1408
    ds_read_b64 v[166:167], v3 offset:1416
    v_mfma_f32_16x16x32_bf16 v[40:43], v[100:103], v[60:63], v[40:43]
    v_mfma_f32_16x16x32_bf16 v[44:47], v[100:103], v[92:95], v[44:47]
    ds_read_b64 v[88:89], v3 offset:1920
    ds_read_b64 v[90:91], v3 offset:1928
    v_mfma_f32_16x16x32_bf16 v[44:47], v[120:123], v[60:63], v[44:47]
    ds_read_b64 v[128:129], v3 offset:448
    ds_read_b64 v[130:131], v3 offset:456
    s_waitcnt lgkmcnt(7)
    v_mfma_f32_16x16x32_bf16 v[32:35], v[64:67], v[140:143], v[32:35]
    ds_read_b128 v[68:71], v4 offset:1984
    ds_read_b128 v[108:111], v4 offset:1472
    v_mfma_f32_16x16x32_bf16 v[36:39], v[64:67], v[160:163], v[36:39]
    ds_read_b128 v[96:99], v4 offset:960
    v_mfma_f32_16x16x32_bf16 v[40:43], v[64:67], v[124:127], v[40:43]
    ds_read_b128 v[152:155], v4 offset:448
    v_mfma_f32_16x16x32_bf16 v[44:47], v[64:67], v[144:147], v[44:47]
    ds_read_b64 v[132:133], v3 offset:960
    ds_read_b64 v[134:135], v3 offset:968
    s_waitcnt lgkmcnt(8)
    v_mfma_f32_16x16x32_bf16 v[36:39], v[84:87], v[140:143], v[36:39]
    v_mfma_f32_16x16x32_bf16 v[40:43], v[84:87], v[160:163], v[40:43]
    v_mfma_f32_16x16x32_bf16 v[44:47], v[84:87], v[124:127], v[44:47]
    ds_read_b64 v[56:57], v3 offset:1472
    ds_read_b64 v[58:59], v3 offset:1480
    v_mfma_f32_16x16x32_bf16 v[40:43], v[164:167], v[140:143], v[40:43]
    v_mfma_f32_16x16x32_bf16 v[44:47], v[164:167], v[160:163], v[44:47]
    ds_read_b64 v[52:53], v3 offset:1984
    ds_read_b64 v[54:55], v3 offset:1992
    v_mfma_f32_16x16x32_bf16 v[44:47], v[88:91], v[140:143], v[44:47]
    s_waitcnt lgkmcnt(9)
    v_mfma_f32_16x16x32_bf16 v[32:35], v[128:131], v[68:71], v[32:35]
    s_waitcnt lgkmcnt(8)
    v_mfma_f32_16x16x32_bf16 v[36:39], v[128:131], v[108:111], v[36:39]
    s_waitcnt lgkmcnt(7)
    v_mfma_f32_16x16x32_bf16 v[40:43], v[128:131], v[96:99], v[40:43]
    s_waitcnt lgkmcnt(6)
    v_mfma_f32_16x16x32_bf16 v[44:47], v[128:131], v[152:155], v[44:47]
    s_waitcnt lgkmcnt(4)
    v_mfma_f32_16x16x32_bf16 v[36:39], v[132:135], v[68:71], v[36:39]
    v_mfma_f32_16x16x32_bf16 v[40:43], v[132:135], v[108:111], v[40:43]
    v_mfma_f32_16x16x32_bf16 v[44:47], v[132:135], v[96:99], v[44:47]
    s_waitcnt lgkmcnt(2)
    v_mfma_f32_16x16x32_bf16 v[40:43], v[56:59], v[68:71], v[40:43]
    v_mfma_f32_16x16x32_bf16 v[44:47], v[56:59], v[108:111], v[44:47]
    s_waitcnt lgkmcnt(0)
    v_mfma_f32_16x16x32_bf16 v[44:47], v[52:55], v[68:71], v[44:47]
    v_cvt_pk_bf16_f32 v48, v32, v33
    v_cvt_pk_bf16_f32 v49, v34, v35
    ds_write_b64 v12, v[48:49] offset:5832
    v_cvt_pk_bf16_f32 v50, v36, v37
    v_cvt_pk_bf16_f32 v51, v38, v39
    ds_write_b64 v12, v[50:51] offset:5320
    v_cvt_pk_bf16_f32 v48, v40, v41
    v_cvt_pk_bf16_f32 v49, v42, v43
    ds_write_b64 v12, v[48:49] offset:4808
    v_cvt_pk_bf16_f32 v50, v44, v45
    v_cvt_pk_bf16_f32 v51, v46, v47
    ds_write_b64 v12, v[50:51] offset:4296
    s_setprio 0
    s_mov_b64 exec, 1
    ds_add_u32 v15, v11 offset:36
    s_mov_b64 exec, -1
    s_endpgm
L_Au:
    s_sub_u32 s7, 11, s3
    s_setprio 3
    s_lshl_b32 s8, s7, 6
    v_add_u32 v2, s8, v0
    v_mul_u32_u24 v3, 9216, v2
    s_lshl_b32 s9, s6, 4
    s_add_u32 s9, s9, 2350080
    v_sub_u32 v3, s9, v3
    v_subrev_u32 v4, 1152, v3
    v_add_u32 v5, 4608, v3
    s_waitcnt lgkmcnt(0)
    s_mov_b32 s44, s16
    s_mov_b32 s45, s17
    s_mov_b32 s46, 2359296
    s_mov_b32 s47, 0x20000
    s_sub_u32 s10, s3, 8
    v_mov_b32 v15, 155136
    v_mov_b32 v11, 1
    s_barrier
    s_mov_b32 s59, 0
    s_branch WI21
WL21:
    s_sleep 1
WI21:
    ds_read_b32 v14, v15 offset:4
    s_add_u32 s59, s59, 1
    s_waitcnt lgkmcnt(0)
    v_cmp_ne_u32 vcc, s10, v14
    s_cmp_ge_u32 s59, 524288
    s_cbranch_scc1 WX21
    s_nop 2
    s_cbranch_vccnz WL21
WX21:
    buffer_load_dwordx4 v[16:19], v5, s[44:47], 0 offen offset:3456
    buffer_load_dwordx4 v[20:23], v5, s[44:47], 0 offen offset:2304
    buffer_load_dwordx4 v[24:27], v5, s[44:47], 0 offen offset:1152
    buffer_load_dwordx4 v[28:31], v5, s[44:47], 0 offen offset:0
    buffer_load_dwordx4 v[32:35], v3, s[44:47], 0 offen offset:3456
    buffer_load_dwordx4 v[36:39], v3, s[44:47], 0 offen offset:2304
    buffer_load_dwordx4 v[40:43], v3, s[44:47], 0 offen offset:1152
    buffer_load_dwordx4 v[44:47], v3, s[44:47], 0 offen offset:0
    buffer_load_dwordx4 v[48:51], v4, s[44:47], 0 offen
    s_mov_b64 exec, 1
    ds_add_u32 v15, v11 offset:4
    s_mov_b64 exec, -1
    v_lshlrev_b32 v6, 4, v2
    v_add_u32 v6, 81920, v6
    s_mov_b32 s14, 0x05040100
    s_mov_b32 s15, 0x07060302
    v_add_u32 v7, 36608, v6
    s_waitcnt vmcnt(1)
    v_perm_b32 v56, v20, v16, s14
    v_perm_b32 v57, v28, v24, s14
    v_perm_b32 v58, v36, v32, s14
    v_perm_b32 v59, v44, v40, s14
    ds_write_b128 v6, v[56:59] offset:4576
    v_perm_b32 v60, v20, v16, s15
    v_perm_b32 v61, v28, v24, s15
    v_perm_b32 v62, v36, v32, s15
    v_perm_b32 v63, v44, v40, s15
    ds_write_b128 v6, v[60:63] offset:13728
    v_perm_b32 v64, v21, v17, s14
    v_perm_b32 v65, v29, v25, s14
    v_perm_b32 v66, v37, v33, s14
    v_perm_b32 v67, v45, v41, s14
    ds_write_b128 v6, v[64:67] offset:22880
    v_perm_b32 v68, v21, v17, s15
    v_perm_b32 v69, v29, v25, s15
    v_perm_b32 v70, v37, v33, s15
    v_perm_b32 v71, v45, v41, s15
    ds_write_b128 v6, v[68:71] offset:32032
    v_perm_b32 v72, v22, v18, s14
    v_perm_b32 v73, v30, v26, s14
    v_perm_b32 v74, v38, v34, s14
    v_perm_b32 v75, v46, v42, s14
    ds_write_b128 v7, v[72:75] offset:4576
    v_perm_b32 v76, v22, v18, s15
    v_perm_b32 v77, v30, v26, s15
    v_perm_b32 v78, v38, v34, s15
    v_perm_b32 v79, v46, v42, s15
    ds_write_b128 v7, v[76:79] offset:13728
    v_perm_b32 v80, v23, v19, s14
    v_perm_b32 v81, v31, v27, s14
    v_perm_b32 v82, v39, v35, s14
    v_perm_b32 v83, v47, v43, s14
    ds_write_b128 v7, v[80:83] offset:22880
    v_perm_b32 v84, v23, v19, s15
    v_perm_b32 v85, v31, v27, s15
    v_perm_b32 v86, v39, v35, s15
    v_perm_b32 v87, v47, v43, s15
    ds_write_b128 v7, v[84:87] offset:32032
    s_waitcnt vmcnt(0)
    v_perm_b32 v56, v24, v20, s14
    v_perm_b32 v57, v32, v28, s14
    v_perm_b32 v58, v40, v36, s14
    v_perm_b32 v59, v48, v44, s14
    ds_write_b128 v6, v[56:59] offset:0
    v_perm_b32 v60, v24, v20, s15
    v_perm_b32 v61, v32, v28, s15
    v_perm_b32 v62, v40, v36, s15
    v_perm_b32 v63, v48, v44, s15
    ds_write_b128 v6, v[60:63] offset:9152
    v_perm_b32 v64, v25, v21, s14
    v_perm_b32 v65, v33, v29, s14
    v_perm_b32 v66, v41, v37, s14
    v_perm_b32 v67, v49, v45, s14
    ds_write_b128 v6, v[64:67] offset:18304
    v_perm_b32 v68, v25, v21, s15
    v_perm_b32 v69, v33, v29, s15
    v_perm_b32 v70, v41, v37, s15
    v_perm_b32 v71, v49, v45, s15
    ds_write_b128 v6, v[68:71] offset:27456
    v_perm_b32 v72, v26, v22, s14
    v_perm_b32 v73, v34, v30, s14
    v_perm_b32 v74, v42, v38, s14
    v_perm_b32 v75, v50, v46, s14
    ds_write_b128 v7, v[72:75] offset:0
    v_perm_b32 v76, v26, v22, s15
    v_perm_b32 v77, v34, v30, s15
    v_perm_b32 v78, v42, v38, s15
    v_perm_b32 v79, v50, v46, s15
    ds_write_b128 v7, v[76:79] offset:9152
    v_perm_b32 v80, v27, v23, s14
    v_perm_b32 v81, v35, v31, s14
    v_perm_b32 v82, v43, v39, s14
    v_perm_b32 v83, v51, v47, s14
    ds_write_b128 v7, v[80:83] offset:18304
    v_perm_b32 v84, v27, v23, s15
    v_perm_b32 v85, v35, v31, s15
    v_perm_b32 v86, v43, v39, s15
    v_perm_b32 v87, v51, v47, s15
    ds_write_b128 v7, v[84:87] offset:27456
    s_mov_b32 s59, 0
    s_branch WI22
WL22:
    s_sleep 1
WI22:
    ds_read_b32 v14, v15 offset:16
    s_add_u32 s59, s59, 1
    s_waitcnt lgkmcnt(0)
    v_cmp_ne_u32 vcc, s10, v14
    s_cmp_ge_u32 s59, 524288
    s_cbranch_scc1 WX22
    s_nop 2
    s_cbranch_vccnz WL22
WX22:
    s_mov_b64 exec, 1
    ds_add_u32 v15, v11 offset:16
    s_mov_b64 exec, -1
    s_mov_b32 s44, s36
    s_mov_b32 s45, s37
    s_mov_b32 s46, 4718592
    s_mov_b32 s47, 0x20000
    v_and_b32 v5, 3, v0
    v_bfe_u32 v6, v0, 2, 2
    v_lshrrev_b32 v7, 4, v0
    v_mul_u32_u24 v3, 8768, v6
    v_lshl_add_u32 v3, v7, 5, v3
    v_lshl_add_u32 v3, v5, 3, v3
    s_lshl_b32 s14, s7, 7
    v_add_u32 v3, s14, v3
    v_lshrrev_b32 v8, 5, v0
    v_xor_b32 v9, v7, v8
    v_and_b32 v9, 1, v9
    v_lshl_add_u32 v9, v9, 2, v6
    v_lshlrev_b32 v9, 5, v9
    v_lshl_add_u32 v9, v5, 1, v9
    v_add_u32 v9, v9, v8
    v_mul_u32_u24 v9, 2304, v9
    s_mul_i32 s12, s7, 18432
    s_lshl_b32 s13, s6, 4
    s_add_u32 s12, s12, s13
    s_mov_b32 s59, 0
    s_branch WI23
WL23:
    s_sleep 2
WI23:
    ds_read_b32 v14, v15 offset:32
    s_add_u32 s59, s59, 1
    s_waitcnt lgkmcnt(0)
    v_cmp_ne_u32 vcc, 8, v14
    s_cmp_ge_u32 s59, 524288
    s_cbranch_scc1 WX23
    s_nop 2
    s_cbranch_vccnz WL23
WX23:
    ds_read_b64_tr_b16 v[20:21], v3 offset:7880
    ds_read_b64_tr_b16 v[22:23], v3 offset:42696
    ds_read_b64_tr_b16 v[24:25], v3 offset:7368
    ds_read_b64_tr_b16 v[26:27], v3 offset:42184
    ds_read_b64_tr_b16 v[28:29], v3 offset:6856
    ds_read_b64_tr_b16 v[30:31], v3 offset:41672
    ds_read_b64_tr_b16 v[32:33], v3 offset:6344
    ds_read_b64_tr_b16 v[34:35], v3 offset:41160
    s_waitcnt lgkmcnt(6)
    buffer_store_dwordx4 v[20:23], v9, s[44:47], s12 offen
    s_add_u32 s12, s12, 589824
    s_waitcnt lgkmcnt(4)
    buffer_store_dwordx4 v[24:27], v9, s[44:47], s12 offen
    s_add_u32 s12, s12, 589824
    s_waitcnt lgkmcnt(2)
    buffer_store_dwordx4 v[28:31], v9, s[44:47], s12 offen
    s_add_u32 s12, s12, 589824
    s_waitcnt lgkmcnt(0)
    buffer_store_dwordx4 v[32:35], v9, s[44:47], s12 offen
    s_add_u32 s12, s12, 589824
    s_mov_b32 s59, 0
    s_branch WI24
WL24:
    s_sleep 2
WI24:
    ds_read_b32 v14, v15 offset:36
    s_add_u32 s59, s59, 1
    s_waitcnt lgkmcnt(0)
    v_cmp_ne_u32 vcc, 8, v14
    s_cmp_ge_u32 s59, 524288
    s_cbranch_scc1 WX24
    s_nop 2
    s_cbranch_vccnz WL24
WX24:
    ds_read_b64_tr_b16 v[36:37], v3 offset:5832
    ds_read_b64_tr_b16 v[38:39], v3 offset:40648
    ds_read_b64_tr_b16 v[40:41], v3 offset:5320
    ds_read_b64_tr_b16 v[42:43], v3 offset:40136
    ds_read_b64_tr_b16 v[44:45], v3 offset:4808
    ds_read_b64_tr_b16 v[46:47], v3 offset:39624
    ds_read_b64_tr_b16 v[48:49], v3 offset:4296
    ds_read_b64_tr_b16 v[50:51], v3 offset:39112
    s_waitcnt lgkmcnt(6)
    buffer_store_dwordx4 v[36:39], v9, s[44:47], s12 offen
    s_add_u32 s12, s12, 589824
    s_waitcnt lgkmcnt(4)
    buffer_store_dwordx4 v[40:43], v9, s[44:47], s12 offen
    s_add_u32 s12, s12, 589824
    s_waitcnt lgkmcnt(2)
    buffer_store_dwordx4 v[44:47], v9, s[44:47], s12 offen
    s_add_u32 s12, s12, 589824
    s_waitcnt lgkmcnt(0)
    buffer_store_dwordx4 v[48:51], v9, s[44:47], s12 offen
    s_add_u32 s12, s12, 589824
    s_endpgm
L_misc:
    v_lshlrev_b32 v2, 4, v0
    s_cmp_ge_u32 s3, 9
    s_cbranch_scc1 L_mo
    s_lshr_b32 s8, s4, 1
    s_and_b32 s9, s4, 1
    s_mul_i32 s10, s8, 165888
    s_lshl_b32 s11, s3, 7
    s_add_u32 s10, s10, s11
    s_lshl_b32 s11, s9, 6
    s_add_u32 s11, s11, s10
    s_mul_i32 s14, s9, 82944
    s_add_u32 s10, s10, s14
    s_mul_i32 s12, s3, 9216
    v_lshrrev_b32 v5, 3, v0
    v_and_b32 v6, 7, v0
    v_mul_u32_u24 v3, 1152, v5
    v_lshl_add_u32 v3, v6, 4, v3
    v_lshrrev_b32 v5, 2, v0
    v_and_b32 v6, 3, v0
    v_and_b32 v7, 3, v5
    v_lshrrev_b32 v8, 5, v0
    v_lshl_add_u32 v7, v8, 2, v7
    v_mul_u32_u24 v7, 18, v7
    v_bfe_u32 v8, v0, 4, 1
    v_add3_u32 v7, v7, v8, 16
    v_mul_u32_u24 v4, 1152, v7
    v_lshl_add_u32 v4, v6, 4, v4
    s_waitcnt lgkmcnt(0)
    s_mov_b32 s44, s34
    s_mov_b32 s45, s35
    s_mov_b32 s46, 663552
    s_mov_b32 s47, 0x20000
    s_mov_b32 s52, s40
    s_mov_b32 s53, s41
    s_mov_b32 s54, 268435456
    s_mov_b32 s55, 0x20000
    s_add_u32 m0, s12, 0
    s_add_u32 s14, s10, 0
    buffer_load_dwordx4 v3, s[44:47], s14 offen lds
    s_add_u32 m0, s12, 1024
    s_add_u32 s14, s10, 9216
    buffer_load_dwordx4 v3, s[44:47], s14 offen lds
    s_add_u32 m0, s12, 2048
    s_add_u32 s14, s10, 20736
    buffer_load_dwordx4 v3, s[44:47], s14 offen lds
    s_add_u32 m0, s12, 3072
    s_add_u32 s14, s10, 29952
    buffer_load_dwordx4 v3, s[44:47], s14 offen lds
    s_add_u32 m0, s12, 4096
    s_add_u32 s14, s10, 41472
    buffer_load_dwordx4 v3, s[44:47], s14 offen lds
    s_add_u32 m0, s12, 5120
    s_add_u32 s14, s10, 50688
    buffer_load_dwordx4 v3, s[44:47], s14 offen lds
    s_add_u32 m0, s12, 6144
    s_add_u32 s14, s10, 62208
    buffer_load_dwordx4 v3, s[44:47], s14 offen lds
    s_add_u32 m0, s12, 7168
    s_add_u32 s14, s10, 71424
    buffer_load_dwordx4 v3, s[44:47], s14 offen lds
    s_add_u32 m0, s12, 8192
    v_lshrrev_b32 v7, 5, v0
    buffer_load_dwordx4 v4, s[44:47], s11 offen lds
    v_bfe_u32 v8, v0, 2, 2
    v_lshl_add_u32 v7, v7, 2, v8
    v_and_b32 v9, 1, v0
    v_lshlrev_b32 v9, 5, v9
    v_bfe_u32 v8, v0, 4, 1
    v_lshl_add_u32 v9, v8, 4, v9
    v_bfe_u32 v8, v0, 1, 1
    v_lshl_add_u32 v9, v8, 3, v9
    v_add_u32 v9, s12, v9
    v_lshl_add_u32 v10, v7, 7, v9
    v_lshl_add_u32 v11, v7, 6, v9
    s_mul_i32 s13, s3, 73728
    s_add_u32 s13, s13, 2555904
    s_mul_i32 s14, s8, 9216
    s_add_u32 s13, s13, s14
    s_mul_i32 s15, s9, 36864
    s_add_u32 s15, s15, s13
    s_add_u32 s15, s15, 8192
    s_lshl_b32 s14, s9, 12
    s_add_u32 s13, s13, s14
    s_add_u32 s14, s13, 36864
    s_waitcnt vmcnt(7)
    ds_read_b64_tr_b16 v[16:17], v10 offset:0
    ds_read_b64_tr_b16 v[18:19], v10 offset:1024
    ds_read_b64_tr_b16 v[20:21], v10 offset:64
    ds_read_b64_tr_b16 v[22:23], v10 offset:1088
    s_waitcnt vmcnt(5)
    ds_read_b64_tr_b16 v[24:25], v10 offset:2048
    ds_read_b64_tr_b16 v[26:27], v10 offset:3072
    ds_read_b64_tr_b16 v[28:29], v10 offset:2112
    ds_read_b64_tr_b16 v[30:31], v10 offset:3136
    s_waitcnt vmcnt(3)
    ds_read_b64_tr_b16 v[32:33], v10 offset:4096
    ds_read_b64_tr_b16 v[34:35], v10 offset:5120
    ds_read_b64_tr_b16 v[36:37], v10 offset:4160
    ds_read_b64_tr_b16 v[38:39], v10 offset:5184
    s_waitcnt vmcnt(1)
    ds_read_b64_tr_b16 v[40:41], v10 offset:6144
    ds_read_b64_tr_b16 v[42:43], v10 offset:7168
    ds_read_b64_tr_b16 v[44:45], v10 offset:6208
    ds_read_b64_tr_b16 v[46:47], v10 offset:7232
    s_waitcnt vmcnt(0)
    ds_read_b64_tr_b16 v[48:49], v11 offset:8192
    ds_read_b64_tr_b16 v[50:51], v11 offset:8704
    s_waitcnt lgkmcnt(15)
    buffer_store_dwordx4 v[16:19], v2, s[52:55], s13 offen offset:0 sc0 sc1
    s_waitcnt lgkmcnt(14)
    buffer_store_dwordx4 v[20:23], v2, s[52:55], s14 offen offset:0 sc0 sc1
    s_waitcnt lgkmcnt(12)
    buffer_store_dwordx4 v[24:27], v2, s[52:55], s13 offen offset:1024 sc0 sc1
    s_waitcnt lgkmcnt(10)
    buffer_store_dwordx4 v[28:31], v2, s[52:55], s14 offen offset:1024 sc0 sc1
    s_waitcnt lgkmcnt(8)
    buffer_store_dwordx4 v[32:35], v2, s[52:55], s13 offen offset:2048 sc0 sc1
    s_waitcnt lgkmcnt(6)
    buffer_store_dwordx4 v[36:39], v2, s[52:55], s14 offen offset:2048 sc0 sc1
    s_waitcnt lgkmcnt(4)
    buffer_store_dwordx4 v[40:43], v2, s[52:55], s13 offen offset:3072 sc0 sc1
    s_waitcnt lgkmcnt(2)
    buffer_store_dwordx4 v[44:47], v2, s[52:55], s14 offen offset:3072 sc0 sc1
    s_waitcnt lgkmcnt(0)
    buffer_store_dwordx4 v[48:51], v2, s[52:55], s15 offen sc0 sc1
    s_cmp_eq_u32 s3, 0
    s_cbranch_scc1 L_m0
    s_waitcnt vmcnt(0)
    s_endpgm
L_m0:
    s_mov_b32 s48, s38
    s_mov_b32 s49, s39
    s_mov_b32 s50, 256
    s_mov_b32 s51, 0x20000
    v_lshlrev_b32 v13, 5, v0
    s_mov_b64 exec, 255
    s_mov_b32 s59, 0
    s_branch PI25
PL25:
    s_sleep 8
PI25:
    buffer_load_dword v14, v13, s[48:51], 0 offen sc0 sc1
PC25:
    s_add_u32 s59, s59, 1
    s_waitcnt vmcnt(0)
    v_cmp_ne_u32 vcc, 1, v14
    s_cmp_ge_u32 s59, 32768
    s_cbranch_scc1 PX25
    s_nop 2
    s_cbranch_vccnz PL25
PX25:
    s_mov_b64 exec, -1
    v_mul_u32_u24 v13, 1024, v0
    v_mov_b32 v3, 1
    s_mov_b32 s14, 3407872
    s_mov_b32 exec_hi, 0
    s_barrier
    buffer_atomic_add v3, v13, s[52:55], s14 offen sc1
    s_endpgm
L_mo:
    s_cmp_eq_u32 s3, 9
    s_cbranch_scc1 L_mzero
    s_endpgm
L_mzero:
    s_setprio 3
    v_mov_b64 v[4:5], 0
    v_mov_b64 v[6:7], 0
    s_mul_i32 s14, s4, 6144
    s_add_u32 s14, s14, 2359296
    v_lshrrev_b32 v3, 3, v0
    v_mul_u32_u24 v8, 0, v3
    v_add_u32 v8, v8, v2
    v_mul_u32_u24 v3, 896, v3
    v_add_u32 v3, v3, v2
    s_mul_i32 s13, s4, 57344
    s_add_u32 s13, s13, 3276800
    s_waitcnt lgkmcnt(0)
    s_mov_b32 s52, s40
    s_mov_b32 s53, s41
    s_mov_b32 s54, 268435456
    s_mov_b32 s55, 0x20000
    buffer_store_dwordx4 v[4:7], v8, s[52:55], s14 offen sc0 sc1
    s_add_u32 s14, s14, 1024
    buffer_store_dwordx4 v[4:7], v8, s[52:55], s14 offen sc0 sc1
    s_add_u32 s14, s14, 1024
    buffer_store_dwordx4 v[4:7], v8, s[52:55], s14 offen sc0 sc1
    s_add_u32 s14, s14, 1024
    buffer_store_dwordx4 v[4:7], v8, s[52:55], s14 offen sc0 sc1
    s_add_u32 s14, s14, 1024
    buffer_store_dwordx4 v[4:7], v8, s[52:55], s14 offen sc0 sc1
    s_add_u32 s14, s14, 1024
    buffer_store_dwordx4 v[4:7], v8, s[52:55], s14 offen sc0 sc1
    s_add_u32 s14, s14, 1024
    buffer_store_dwordx4 v[4:7], v3, s[52:55], s13 offen sc0 sc1
    s_add_u32 s13, s13, 8192
    buffer_store_dwordx4 v[4:7], v3, s[52:55], s13 offen sc0 sc1
    s_add_u32 s13, s13, 8192
    buffer_store_dwordx4 v[4:7], v3, s[52:55], s13 offen sc0 sc1
    s_add_u32 s13, s13, 8192
    buffer_store_dwordx4 v[4:7], v3, s[52:55], s13 offen sc0 sc1
    s_add_u32 s13, s13, 8192
    buffer_store_dwordx4 v[4:7], v3, s[52:55], s13 offen sc0 sc1
    s_add_u32 s13, s13, 8192
    buffer_store_dwordx4 v[4:7], v3, s[52:55], s13 offen sc0 sc1
    s_add_u32 s13, s13, 8192
    buffer_store_dwordx4 v[4:7], v3, s[52:55], s13 offen sc0 sc1
    s_mov_b32 s48, s38
    s_mov_b32 s49, s39
    s_mov_b32 s50, 256
    s_mov_b32 s51, 0x20000
    s_lshl_b32 s14, s4, 5
    v_mov_b32 v5, 1
    s_mov_b64 exec, 1
    s_waitcnt vmcnt(0)
    buffer_store_dword v5, v4, s[48:51], s14 offen sc0 sc1
    s_endpgm
L_codeend:
    s_endpgm
.section .rodata,"a"
.p2align 6
.amdhsa_kernel concat_heads__ssm_conv_s4d__linear_attn_block__prompt_kernel
  .amdhsa_next_free_vgpr 168
  .amdhsa_next_free_sgpr 102
  .amdhsa_accum_offset 168
  .amdhsa_group_segment_fixed_size 0
  .amdhsa_kernarg_size 104
  .amdhsa_user_sgpr_count 2
  .amdhsa_user_sgpr_kernarg_segment_ptr 1
  .amdhsa_system_sgpr_workgroup_id_x 1
.end_amdhsa_kernel
```
